```python
import torch

def _softmax(x, axis=-1):
    return torch.softmax(x, dim=axis)
def _gelu(x):
    return torch.nn.functional.gelu(x, approximate="tanh")
def _silu(x):
    return torch.nn.functional.silu(x)
def _sigmoid(x):
    return torch.sigmoid(x)
def _layernorm(x, axis=-1, eps=1e-5):
    m = x.mean(dim=axis, keepdim=True)
    v = x.var(dim=axis, keepdim=True, unbiased=False)
    return (x - m) / torch.sqrt(v + eps)
def _scatter_add(tgt, idx, src, axis=0):
    return tgt.clone().index_add_(axis, idx, src)
def _segment_sum(src, seg, n):
    out = torch.zeros((n,) + src.shape[1:], dtype=src.dtype)
    return out.index_add_(0, seg, src)
def _pad(x, pw):
    flat = tuple(v for pair in reversed(pw) for v in pair)
    return torch.nn.functional.pad(x, flat)

kernel_name = 'sequential_preLN__ssm_conv_s4__glu_gated_swiglu__prompt'

def setup_inputs():

    _w = (lambda a: (lambda t: t.to(torch.bfloat16) if t.is_floating_point() else t)(torch.as_tensor(a)))
    def _A_setup():
        B, L, D, N = 1, 2048, 640, 128
        A_re = -(lambda _x: torch.exp(torch.as_tensor(_x)))((lambda *s: torch.randn(*s, dtype=torch.bfloat16) * 6.4)(D, N))
        A_im = torch.pi * (lambda *s: torch.randn(*s, dtype=torch.bfloat16) * 0.05)(D, N)
        B_re = (lambda *s: torch.randn(*s, dtype=torch.bfloat16) * 0.05)(D, N)
        B_im = (lambda *s: torch.randn(*s, dtype=torch.bfloat16) * 0.05)(D, N)
        C_re = (lambda *s: torch.randn(*s, dtype=torch.bfloat16) * 0.05)(D, N)
        C_im = (lambda *s: torch.randn(*s, dtype=torch.bfloat16) * 0.05)(D, N)
        log_dt = (lambda *s: torch.randn(*s, dtype=torch.bfloat16) * 0.05)(D) * 0.5 - 4.0
        Dskip = (lambda *s: torch.randn(*s, dtype=torch.bfloat16) * 0.05)(D)
        return {
            "u": _w((lambda *s: torch.randn(*s, dtype=torch.bfloat16) * 0.05)(B, L, D)),
            "A_re": _w(A_re),
            "A_im": _w(A_im),
            "B_re": _w(B_re),
            "B_im": _w(B_im),
            "C_re": _w(C_re),
            "C_im": _w(C_im),
            "log_dt": _w(log_dt),
            "Dskip": _w(Dskip),
        }
    _A_in = _A_setup()

    def _B_setup():
        B, S, D, F = 1, 2048, 640, 1728
        return {
            "x": _w((lambda *s: torch.randn(*s, dtype=torch.bfloat16) * 0.05)(B, S, D)),
            "w1": _w((lambda *s: torch.randn(*s, dtype=torch.bfloat16) * 0.4)(D, F) * (2.0 / D) ** 0.5),
            "w3": _w((lambda *s: torch.randn(*s, dtype=torch.bfloat16) * 0.4)(D, F) * (2.0 / D) ** 0.5),
            "w2": _w((lambda *s: torch.randn(*s, dtype=torch.bfloat16) * 0.4)(F, D) * (2.0 / F) ** 0.5),
        }
    _B_in = _B_setup()

    return {
        "A_u": _A_in["u"],
        "A_A_re": _A_in["A_re"],
        "A_A_im": _A_in["A_im"],
        "A_B_re": _A_in["B_re"],
        "A_B_im": _A_in["B_im"],
        "A_C_re": _A_in["C_re"],
        "A_C_im": _A_in["C_im"],
        "A_log_dt": _A_in["log_dt"],
        "A_Dskip": _A_in["Dskip"],
        "B_x": _B_in["x"],
        "B_w1": _B_in["w1"],
        "B_w3": _B_in["w3"],
        "B_w2": _B_in["w2"],
    }

def reference(A_u, A_A_re, A_A_im, A_B_re, A_B_im, A_C_re, A_C_im, A_log_dt, A_Dskip, B_x, B_w1, B_w3, B_w2):
    def _A_ref(u, A_re, A_im, B_re, B_im, C_re, C_im, log_dt, Dskip):
        Bsz, L, D = u.shape
        dt = torch.exp(log_dt)[:, None]
        A = A_re + 1j * A_im
        Bc = B_re + 1j * B_im
        Cc = C_re + 1j * C_im
        logdA = dt * A
        dB = dt * Bc
        l = (lambda x, dt: x.to(dt))(torch.arange(L), A_re.dtype)
        P = torch.exp(logdA[:, :, None] * l[None, None, :])
        K = torch.einsum("dn,dnl,dn->dl", Cc, P, dB).real
        L2 = 2 * L
        Kp = _pad(K, ((0, 0), (0, L)))
        up = (lambda x, *d: x.permute(*d))(u, 0, 2, 1)
        up = _pad(up, ((0, 0), (0, 0), (0, L)))
        Kf = (lambda x, axes=(-2,-1): torch.fft.rfft2(x.float(), dim=axes))(Kp[:, None, :], axes=(-2, -1))
        Uf = (lambda x, axes=(-2,-1): torch.fft.rfft2(x.float(), dim=axes))(up[:, :, None, :], axes=(-2, -1))
        Yf = Uf * Kf[None, :, :, :]
        y = (lambda x, s, axes=(-2,-1): torch.fft.irfft2(x, s=s, dim=axes).to(torch.bfloat16))(Yf, (1, L2), axes=(-2, -1))[:, :, 0, :L]
        y = (lambda x, *d: x.permute(*d))(y, 0, 2, 1) + u * Dskip[None, None, :]
        return y

    def _B_ref(x, w1, w3, w2):
        gate = torch.einsum("bsd,df->bsf", x, w1)
        up = torch.einsum("bsd,df->bsf", x, w3)
        h = _silu(gate) * up
        out = torch.einsum("bsf,fd->bsd", h, w2)
        return out

    x = A_u
    h = x + _A_ref(_layernorm(x, axis=-1), A_A_re, A_A_im, A_B_re, A_B_im, A_C_re, A_C_im, A_log_dt, A_Dskip)
    h2 = h + _B_ref(_layernorm(h, axis=-1), B_w1, B_w3, B_w2)
    return h2
```

```asm
; @launch grid=(256,1,1) block=(512,1,1) lds=151552
.amdgcn_target "amdgcn-amd-amdhsa--gfx950"
.text
.globl sequential_preLN__ssm_conv_s4__glu_gated_swiglu__prompt_kernel
.p2align 8
.type sequential_preLN__ssm_conv_s4__glu_gated_swiglu__prompt_kernel,@function
sequential_preLN__ssm_conv_s4__glu_gated_swiglu__prompt_kernel:
    s_cmp_ge_u32 s2, 256
    s_cbranch_scc1 L_fm_exit
    v_cmp_gt_u32 vcc, 64, v0
    s_nop 0
    s_and_saveexec_b64 s[90:91], vcc
    s_cbranch_execz L_pcskip_fm
    s_getpc_b64 s[88:89]
L_pc_fm:
    s_sub_u32 s88, s88, L_pc_fm - sequential_preLN__ssm_conv_s4__glu_gated_swiglu__prompt_kernel
    s_subb_u32 s89, s89, 0
    v_lshlrev_b32 v250, 7, v0
    global_load_dword v251, v250, s[88:89]
    v_add_u32 v250, 8192, v250
    v_min_u32 v250, 12160, v250
    global_load_dword v251, v250, s[88:89]
L_pcskip_fm:
    s_mov_b64 exec, s[90:91]
    s_load_dwordx2 s[6:7], s[0:1], 120
    s_load_dwordx2 s[4:5], s[0:1], 0
    s_load_dwordx2 s[80:81], s[0:1], 80
    s_load_dwordx2 s[82:83], s[0:1], 88
    s_load_dwordx2 s[84:85], s[0:1], 96
    v_lshrrev_b32 v2, 6, v0
    v_and_b32 v1, 63, v0
    s_nop 0
    v_readfirstlane_b32 s24, v2
    s_cmp_lt_u32 s2, 64
    s_cbranch_scc1 L_fm_ln
    s_cmp_lt_u32 s2, 224
    s_cbranch_scc1 L_fm_kg
    s_waitcnt lgkmcnt(0)
    v_cmp_gt_u32 vcc, 64, v0
    s_nop 0
    s_and_saveexec_b64 s[90:91], vcc
    s_cbranch_execz L_pcskip_fmn
    s_getpc_b64 s[88:89]
L_pc_fmn:
    s_add_u32 s88, s88, L_ffn_begin - L_pc_fmn
    s_addc_u32 s89, s89, 0
    v_lshlrev_b32 v246, 7, v0
    global_load_dword v247, v246, s[88:89]
    v_add_u32 v246, 8192, v246
    global_load_dword v247, v246, s[88:89]
    v_add_u32 v246, 8192, v246
    v_min_u32 v246, L_ffn_end_f - L_ffn_begin - 128, v246
    global_load_dword v247, v246, s[88:89]
L_pcskip_fmn:
    s_mov_b64 exec, s[90:91]
    s_waitcnt vmcnt(0)
    s_sub_u32 s25, s2, 160
L_fm_repack:
    s_cmp_ge_u32 s24, 4
    s_cbranch_scc1 L_fm_end
    s_lshl_b32 s25, s25, 2
    s_add_u32 s52, s25, s24
    s_mul_i32 s25, s24, 20480
    s_cmp_ge_u32 s52, 326
    s_cbranch_scc1 L_fm_end
    s_cmp_ge_u32 s52, 216
    s_cselect_b32 s62, 1, 0
    s_cbranch_scc1 L_rp_w2_m
    s_lshr_b32 s57, s52, 2
    s_and_b32 s55, s52, 3
    s_cmp_ge_u32 s57, 27
    s_cselect_b32 s53, 1, 0
    s_mul_i32 s58, s53, 27
    s_sub_u32 s54, s57, s58
    s_cmp_eq_u32 s53, 0
    s_cselect_b32 s40, s80, s82
    s_cselect_b32 s41, s81, s83
    s_mov_b32 s42, 2211840
    s_mov_b32 s43, 131072
    s_movk_i32 s56, 3456
    s_add_u32 s44, s6, 23068672
    s_addc_u32 s45, s7, 0
    s_mov_b32 s46, 4423680
    s_mov_b32 s47, 131072
    s_mul_i32 s60, s55, 1105920
    s_lshl_b32 s57, s54, 13
    s_add_u32 s60, s60, s57
    s_lshl_b32 s57, s53, 10
    s_add_u32 s60, s60, s57
    s_mov_b32 s61, 221184
    s_branch L_rp_go_m
L_rp_w2_m:
    s_sub_u32 s57, s52, 216
    s_mul_i32 s54, s57, 5958
    s_lshr_b32 s54, s54, 16
    s_mul_i32 s58, s54, 11
    s_sub_u32 s55, s57, s58
    s_mov_b32 s53, 0
    s_mov_b32 s40, s84
    s_mov_b32 s41, s85
    s_mov_b32 s42, 2211840
    s_mov_b32 s43, 131072
    s_movk_i32 s56, 1280
    s_add_u32 s44, s6, 28311552
    s_addc_u32 s45, s7, 0
    s_mov_b32 s46, 2211840
    s_mov_b32 s47, 131072
    s_mul_i32 s60, s55, 204800
    s_lshl_b32 s57, s54, 12
    s_add_u32 s60, s60, s57
    s_mov_b32 s61, 40960
L_rp_go_m:
    v_lshrrev_b32 v9, 3, v1
    v_and_b32 v10, 7, v1
    v_and_b32 v11, 6, v9
    v_xor_b32 v10, v10, v11
    v_lshlrev_b32 v10, 4, v10
    v_mul_lo_u32 v8, v9, s56
    v_add_u32 v8, v8, v10
    s_lshl_b32 s57, s54, 7
    v_add_u32 v8, s57, v8
    s_mul_i32 s59, s55, 160
    s_mul_i32 s59, s59, s56
    s_lshl_b32 s58, s56, 3
    s_add_u32 m0, s25, 0
    s_nop 0
    buffer_load_dwordx4 v8, s[40:43], s59 offen lds
    s_add_u32 s59, s59, s58
    s_add_u32 m0, s25, 1024
    s_nop 0
    buffer_load_dwordx4 v8, s[40:43], s59 offen lds
    s_add_u32 s59, s59, s58
    s_add_u32 m0, s25, 2048
    s_nop 0
    buffer_load_dwordx4 v8, s[40:43], s59 offen lds
    s_add_u32 s59, s59, s58
    s_add_u32 m0, s25, 3072
    s_nop 0
    buffer_load_dwordx4 v8, s[40:43], s59 offen lds
    s_add_u32 s59, s59, s58
    s_add_u32 m0, s25, 4096
    s_nop 0
    buffer_load_dwordx4 v8, s[40:43], s59 offen lds
    s_add_u32 s59, s59, s58
    s_add_u32 m0, s25, 5120
    s_nop 0
    buffer_load_dwordx4 v8, s[40:43], s59 offen lds
    s_add_u32 s59, s59, s58
    s_add_u32 m0, s25, 6144
    s_nop 0
    buffer_load_dwordx4 v8, s[40:43], s59 offen lds
    s_add_u32 s59, s59, s58
    s_add_u32 m0, s25, 7168
    s_nop 0
    buffer_load_dwordx4 v8, s[40:43], s59 offen lds
    s_add_u32 s59, s59, s58
    s_add_u32 m0, s25, 8192
    s_nop 0
    buffer_load_dwordx4 v8, s[40:43], s59 offen lds
    s_add_u32 s59, s59, s58
    s_add_u32 m0, s25, 9216
    s_nop 0
    buffer_load_dwordx4 v8, s[40:43], s59 offen lds
    s_add_u32 s59, s59, s58
    s_add_u32 m0, s25, 10240
    s_nop 0
    buffer_load_dwordx4 v8, s[40:43], s59 offen lds
    s_add_u32 s59, s59, s58
    s_add_u32 m0, s25, 11264
    s_nop 0
    buffer_load_dwordx4 v8, s[40:43], s59 offen lds
    s_add_u32 s59, s59, s58
    s_add_u32 m0, s25, 12288
    s_nop 0
    buffer_load_dwordx4 v8, s[40:43], s59 offen lds
    s_add_u32 s59, s59, s58
    s_add_u32 m0, s25, 13312
    s_nop 0
    buffer_load_dwordx4 v8, s[40:43], s59 offen lds
    s_add_u32 s59, s59, s58
    s_add_u32 m0, s25, 14336
    s_nop 0
    buffer_load_dwordx4 v8, s[40:43], s59 offen lds
    s_add_u32 s59, s59, s58
    s_add_u32 m0, s25, 15360
    s_nop 0
    buffer_load_dwordx4 v8, s[40:43], s59 offen lds
    s_add_u32 s59, s59, s58
    s_add_u32 m0, s25, 16384
    s_nop 0
    buffer_load_dwordx4 v8, s[40:43], s59 offen lds
    s_add_u32 s59, s59, s58
    s_add_u32 m0, s25, 17408
    s_nop 0
    buffer_load_dwordx4 v8, s[40:43], s59 offen lds
    s_add_u32 s59, s59, s58
    s_add_u32 m0, s25, 18432
    s_nop 0
    buffer_load_dwordx4 v8, s[40:43], s59 offen lds
    s_add_u32 s59, s59, s58
    s_add_u32 m0, s25, 19456
    s_nop 0
    buffer_load_dwordx4 v8, s[40:43], s59 offen lds
    s_add_u32 s59, s59, s58
    v_lshrrev_b32 v9, 4, v1
    v_bfe_u32 v11, v1, 2, 2
    v_lshl_add_u32 v9, v9, 2, v11
    v_lshrrev_b32 v11, 3, v9
    v_lshlrev_b32 v11, 10, v11
    v_and_b32 v12, 7, v9
    v_lshl_add_u32 v11, v12, 7, v11
    v_and_b32 v12, 1, v1
    v_lshl_add_u32 v11, v12, 3, v11
    v_add_u32 v11, s25, v11
    v_bfe_u32 v12, v1, 1, 1
    v_and_b32 v9, 6, v9
    v_or_b32 v10, 0, v12
    v_xor_b32 v10, v10, v9
    v_lshl_add_u32 v40, v10, 4, v11
    v_or_b32 v10, 2, v12
    v_xor_b32 v10, v10, v9
    v_lshl_add_u32 v41, v10, 4, v11
    v_or_b32 v10, 4, v12
    v_xor_b32 v10, v10, v9
    v_lshl_add_u32 v42, v10, 4, v11
    v_or_b32 v10, 6, v12
    v_xor_b32 v10, v10, v9
    v_lshl_add_u32 v43, v10, 4, v11
    v_lshlrev_b32 v10, 4, v1
    v_add_u32 v10, s60, v10
    v_mov_b32 v36, 0x3f803f80
    v_mov_b32 v32, 0
    v_mov_b32 v33, 0
    v_mov_b32 v34, 0
    v_mov_b32 v35, 0
    s_mov_b32 s59, 0
    s_lshr_b32 s58, 2048, s62
    s_waitcnt vmcnt(0)
    ds_read_b64_tr_b16 v[16:17], v40 offset:0
    ds_read_b64_tr_b16 v[18:19], v40 offset:2048
    ds_read_b64_tr_b16 v[20:21], v41 offset:0
    ds_read_b64_tr_b16 v[22:23], v41 offset:2048
    ds_read_b64_tr_b16 v[24:25], v42 offset:0
    ds_read_b64_tr_b16 v[26:27], v42 offset:2048
    ds_read_b64_tr_b16 v[28:29], v43 offset:0
    ds_read_b64_tr_b16 v[30:31], v43 offset:2048
    s_mov_b32 s57, s59
    s_waitcnt lgkmcnt(6)
    buffer_store_dwordx4 v[16:19], v10, s[44:47], s57 offen sc1
    v_dot2_f32_bf16 v32, v16, v36, v32
    v_dot2_f32_bf16 v32, v17, v36, v32
    v_dot2_f32_bf16 v32, v18, v36, v32
    v_dot2_f32_bf16 v32, v19, v36, v32
    s_add_u32 s57, s57, s58
    s_waitcnt lgkmcnt(4)
    buffer_store_dwordx4 v[20:23], v10, s[44:47], s57 offen sc1
    v_dot2_f32_bf16 v33, v20, v36, v33
    v_dot2_f32_bf16 v33, v21, v36, v33
    v_dot2_f32_bf16 v33, v22, v36, v33
    v_dot2_f32_bf16 v33, v23, v36, v33
    s_add_u32 s57, s57, s58
    s_waitcnt lgkmcnt(2)
    buffer_store_dwordx4 v[24:27], v10, s[44:47], s57 offen sc1
    v_dot2_f32_bf16 v34, v24, v36, v34
    v_dot2_f32_bf16 v34, v25, v36, v34
    v_dot2_f32_bf16 v34, v26, v36, v34
    v_dot2_f32_bf16 v34, v27, v36, v34
    s_add_u32 s57, s57, s58
    s_waitcnt lgkmcnt(0)
    buffer_store_dwordx4 v[28:31], v10, s[44:47], s57 offen sc1
    v_dot2_f32_bf16 v35, v28, v36, v35
    v_dot2_f32_bf16 v35, v29, v36, v35
    v_dot2_f32_bf16 v35, v30, v36, v35
    v_dot2_f32_bf16 v35, v31, v36, v35
    s_add_u32 s57, s57, s58
    s_add_u32 s59, s59, s61
    ds_read_b64_tr_b16 v[16:17], v40 offset:4096
    ds_read_b64_tr_b16 v[18:19], v40 offset:6144
    ds_read_b64_tr_b16 v[20:21], v41 offset:4096
    ds_read_b64_tr_b16 v[22:23], v41 offset:6144
    ds_read_b64_tr_b16 v[24:25], v42 offset:4096
    ds_read_b64_tr_b16 v[26:27], v42 offset:6144
    ds_read_b64_tr_b16 v[28:29], v43 offset:4096
    ds_read_b64_tr_b16 v[30:31], v43 offset:6144
    s_mov_b32 s57, s59
    s_waitcnt lgkmcnt(6)
    buffer_store_dwordx4 v[16:19], v10, s[44:47], s57 offen sc1
    v_dot2_f32_bf16 v32, v16, v36, v32
    v_dot2_f32_bf16 v32, v17, v36, v32
    v_dot2_f32_bf16 v32, v18, v36, v32
    v_dot2_f32_bf16 v32, v19, v36, v32
    s_add_u32 s57, s57, s58
    s_waitcnt lgkmcnt(4)
    buffer_store_dwordx4 v[20:23], v10, s[44:47], s57 offen sc1
    v_dot2_f32_bf16 v33, v20, v36, v33
    v_dot2_f32_bf16 v33, v21, v36, v33
    v_dot2_f32_bf16 v33, v22, v36, v33
    v_dot2_f32_bf16 v33, v23, v36, v33
    s_add_u32 s57, s57, s58
    s_waitcnt lgkmcnt(2)
    buffer_store_dwordx4 v[24:27], v10, s[44:47], s57 offen sc1
    v_dot2_f32_bf16 v34, v24, v36, v34
    v_dot2_f32_bf16 v34, v25, v36, v34
    v_dot2_f32_bf16 v34, v26, v36, v34
    v_dot2_f32_bf16 v34, v27, v36, v34
    s_add_u32 s57, s57, s58
    s_waitcnt lgkmcnt(0)
    buffer_store_dwordx4 v[28:31], v10, s[44:47], s57 offen sc1
    v_dot2_f32_bf16 v35, v28, v36, v35
    v_dot2_f32_bf16 v35, v29, v36, v35
    v_dot2_f32_bf16 v35, v30, v36, v35
    v_dot2_f32_bf16 v35, v31, v36, v35
    s_add_u32 s57, s57, s58
    s_add_u32 s59, s59, s61
    ds_read_b64_tr_b16 v[16:17], v40 offset:8192
    ds_read_b64_tr_b16 v[18:19], v40 offset:10240
    ds_read_b64_tr_b16 v[20:21], v41 offset:8192
    ds_read_b64_tr_b16 v[22:23], v41 offset:10240
    ds_read_b64_tr_b16 v[24:25], v42 offset:8192
    ds_read_b64_tr_b16 v[26:27], v42 offset:10240
    ds_read_b64_tr_b16 v[28:29], v43 offset:8192
    ds_read_b64_tr_b16 v[30:31], v43 offset:10240
    s_mov_b32 s57, s59
    s_waitcnt lgkmcnt(6)
    buffer_store_dwordx4 v[16:19], v10, s[44:47], s57 offen sc1
    v_dot2_f32_bf16 v32, v16, v36, v32
    v_dot2_f32_bf16 v32, v17, v36, v32
    v_dot2_f32_bf16 v32, v18, v36, v32
    v_dot2_f32_bf16 v32, v19, v36, v32
    s_add_u32 s57, s57, s58
    s_waitcnt lgkmcnt(4)
    buffer_store_dwordx4 v[20:23], v10, s[44:47], s57 offen sc1
    v_dot2_f32_bf16 v33, v20, v36, v33
    v_dot2_f32_bf16 v33, v21, v36, v33
    v_dot2_f32_bf16 v33, v22, v36, v33
    v_dot2_f32_bf16 v33, v23, v36, v33
    s_add_u32 s57, s57, s58
    s_waitcnt lgkmcnt(2)
    buffer_store_dwordx4 v[24:27], v10, s[44:47], s57 offen sc1
    v_dot2_f32_bf16 v34, v24, v36, v34
    v_dot2_f32_bf16 v34, v25, v36, v34
    v_dot2_f32_bf16 v34, v26, v36, v34
    v_dot2_f32_bf16 v34, v27, v36, v34
    s_add_u32 s57, s57, s58
    s_waitcnt lgkmcnt(0)
    buffer_store_dwordx4 v[28:31], v10, s[44:47], s57 offen sc1
    v_dot2_f32_bf16 v35, v28, v36, v35
    v_dot2_f32_bf16 v35, v29, v36, v35
    v_dot2_f32_bf16 v35, v30, v36, v35
    v_dot2_f32_bf16 v35, v31, v36, v35
    s_add_u32 s57, s57, s58
    s_add_u32 s59, s59, s61
    ds_read_b64_tr_b16 v[16:17], v40 offset:12288
    ds_read_b64_tr_b16 v[18:19], v40 offset:14336
    ds_read_b64_tr_b16 v[20:21], v41 offset:12288
    ds_read_b64_tr_b16 v[22:23], v41 offset:14336
    ds_read_b64_tr_b16 v[24:25], v42 offset:12288
    ds_read_b64_tr_b16 v[26:27], v42 offset:14336
    ds_read_b64_tr_b16 v[28:29], v43 offset:12288
    ds_read_b64_tr_b16 v[30:31], v43 offset:14336
    s_mov_b32 s57, s59
    s_waitcnt lgkmcnt(6)
    buffer_store_dwordx4 v[16:19], v10, s[44:47], s57 offen sc1
    v_dot2_f32_bf16 v32, v16, v36, v32
    v_dot2_f32_bf16 v32, v17, v36, v32
    v_dot2_f32_bf16 v32, v18, v36, v32
    v_dot2_f32_bf16 v32, v19, v36, v32
    s_add_u32 s57, s57, s58
    s_waitcnt lgkmcnt(4)
    buffer_store_dwordx4 v[20:23], v10, s[44:47], s57 offen sc1
    v_dot2_f32_bf16 v33, v20, v36, v33
    v_dot2_f32_bf16 v33, v21, v36, v33
    v_dot2_f32_bf16 v33, v22, v36, v33
    v_dot2_f32_bf16 v33, v23, v36, v33
    s_add_u32 s57, s57, s58
    s_waitcnt lgkmcnt(2)
    buffer_store_dwordx4 v[24:27], v10, s[44:47], s57 offen sc1
    v_dot2_f32_bf16 v34, v24, v36, v34
    v_dot2_f32_bf16 v34, v25, v36, v34
    v_dot2_f32_bf16 v34, v26, v36, v34
    v_dot2_f32_bf16 v34, v27, v36, v34
    s_add_u32 s57, s57, s58
    s_waitcnt lgkmcnt(0)
    buffer_store_dwordx4 v[28:31], v10, s[44:47], s57 offen sc1
    v_dot2_f32_bf16 v35, v28, v36, v35
    v_dot2_f32_bf16 v35, v29, v36, v35
    v_dot2_f32_bf16 v35, v30, v36, v35
    v_dot2_f32_bf16 v35, v31, v36, v35
    s_add_u32 s57, s57, s58
    s_add_u32 s59, s59, s61
    ds_read_b64_tr_b16 v[16:17], v40 offset:16384
    ds_read_b64_tr_b16 v[18:19], v40 offset:18432
    ds_read_b64_tr_b16 v[20:21], v41 offset:16384
    ds_read_b64_tr_b16 v[22:23], v41 offset:18432
    ds_read_b64_tr_b16 v[24:25], v42 offset:16384
    ds_read_b64_tr_b16 v[26:27], v42 offset:18432
    ds_read_b64_tr_b16 v[28:29], v43 offset:16384
    ds_read_b64_tr_b16 v[30:31], v43 offset:18432
    s_mov_b32 s57, s59
    s_waitcnt lgkmcnt(6)
    buffer_store_dwordx4 v[16:19], v10, s[44:47], s57 offen sc1
    v_dot2_f32_bf16 v32, v16, v36, v32
    v_dot2_f32_bf16 v32, v17, v36, v32
    v_dot2_f32_bf16 v32, v18, v36, v32
    v_dot2_f32_bf16 v32, v19, v36, v32
    s_add_u32 s57, s57, s58
    s_waitcnt lgkmcnt(4)
    buffer_store_dwordx4 v[20:23], v10, s[44:47], s57 offen sc1
    v_dot2_f32_bf16 v33, v20, v36, v33
    v_dot2_f32_bf16 v33, v21, v36, v33
    v_dot2_f32_bf16 v33, v22, v36, v33
    v_dot2_f32_bf16 v33, v23, v36, v33
    s_add_u32 s57, s57, s58
    s_waitcnt lgkmcnt(2)
    buffer_store_dwordx4 v[24:27], v10, s[44:47], s57 offen sc1
    v_dot2_f32_bf16 v34, v24, v36, v34
    v_dot2_f32_bf16 v34, v25, v36, v34
    v_dot2_f32_bf16 v34, v26, v36, v34
    v_dot2_f32_bf16 v34, v27, v36, v34
    s_add_u32 s57, s57, s58
    s_waitcnt lgkmcnt(0)
    buffer_store_dwordx4 v[28:31], v10, s[44:47], s57 offen sc1
    v_dot2_f32_bf16 v35, v28, v36, v35
    v_dot2_f32_bf16 v35, v29, v36, v35
    v_dot2_f32_bf16 v35, v30, v36, v35
    v_dot2_f32_bf16 v35, v31, v36, v35
    s_add_u32 s57, s57, s58
    s_add_u32 s59, s59, s61
    s_cmp_eq_u32 s62, 0
    s_cbranch_scc0 L_rp_done_m
    v_mov_b32 v9, v32
    s_nop 1
    v_permlane16_swap_b32 v32, v9
    s_nop 1
    v_add_f32 v32, v32, v9
    v_mov_b32 v9, v32
    s_nop 1
    v_permlane32_swap_b32 v32, v9
    s_nop 1
    v_add_f32 v32, v32, v9
    v_mov_b32 v9, v33
    s_nop 1
    v_permlane16_swap_b32 v33, v9
    s_nop 1
    v_add_f32 v33, v33, v9
    v_mov_b32 v9, v33
    s_nop 1
    v_permlane32_swap_b32 v33, v9
    s_nop 1
    v_add_f32 v33, v33, v9
    v_mov_b32 v9, v34
    s_nop 1
    v_permlane16_swap_b32 v34, v9
    s_nop 1
    v_add_f32 v34, v34, v9
    v_mov_b32 v9, v34
    s_nop 1
    v_permlane32_swap_b32 v34, v9
    s_nop 1
    v_add_f32 v34, v34, v9
    v_mov_b32 v9, v35
    s_nop 1
    v_permlane16_swap_b32 v35, v9
    s_nop 1
    v_add_f32 v35, v35, v9
    v_mov_b32 v9, v35
    s_nop 1
    v_permlane32_swap_b32 v35, v9
    s_nop 1
    v_add_f32 v35, v35, v9
    v_lshrrev_b32 v9, 4, v1
    v_cmp_eq_u32 vcc, 1, v9
    s_nop 1
    v_cndmask_b32 v32, v32, v33, vcc
    v_cmp_eq_u32 vcc, 2, v9
    s_nop 1
    v_cndmask_b32 v32, v32, v34, vcc
    v_cmp_eq_u32 vcc, 3, v9
    s_nop 1
    v_cndmask_b32 v32, v32, v35, vcc
    s_add_u32 s48, s6, 20971520
    s_addc_u32 s49, s7, 0
    s_mov_b32 s50, 55296
    s_mov_b32 s51, 131072
    s_mul_i32 s57, s55, 13824
    s_mul_i32 s58, s53, 6912
    s_add_u32 s57, s57, s58
    s_lshl_b32 s58, s54, 8
    s_add_u32 s57, s57, s58
    v_lshlrev_b32 v9, 2, v1
    buffer_store_dword v32, v9, s[48:51], s57 offen sc1
L_rp_done_m:
    s_branch L_fm_end
L_fm_ln:
    s_waitcnt lgkmcnt(0)
    s_mov_b32 s8, s4
    s_mov_b32 s9, s5
    s_mov_b32 s10, 2621440
    s_mov_b32 s11, 131072
    s_mov_b32 s12, s6
    s_mov_b32 s13, s7
    s_mov_b32 s14, 2621440
    s_mov_b32 s15, 131072
    s_add_u32 s16, s6, 21069824
    s_addc_u32 s17, s7, 0
    s_mov_b32 s18, 16384
    s_mov_b32 s19, 131072
    s_load_dwordx2 s[76:77], s[0:1], 112
    s_waitcnt lgkmcnt(0)
    s_mov_b32 s78, 256
    s_mov_b32 s79, 131072
    s_add_u32 s40, s6, 21037056
    s_addc_u32 s41, s7, 0
    s_mov_b32 s42, 16384
    s_mov_b32 s43, 131072
    s_add_u32 s44, s6, 21102592
    s_addc_u32 s45, s7, 0
    s_mov_b32 s46, 65536
    s_mov_b32 s47, 131072
    s_cmp_eq_u32 s24, 7
    s_cbranch_scc0 L_fm_noini
    v_lshlrev_b32 v100, 4, v1
    v_mov_b32 v104, -1
    v_mov_b32 v105, -1
    v_mov_b32 v106, -1
    v_mov_b32 v107, -1
    s_lshl_b32 s48, s2, 8
    s_mov_b64 exec, 0xffff
    buffer_store_dwordx4 v[104:107], v100, s[40:43], s48 offen sc1
    v_mov_b32 v108, 0
    v_mov_b32 v109, 0
    v_mov_b32 v110, 0
    v_mov_b32 v111, 0
    s_lshl_b32 s48, s2, 7
    s_mov_b64 exec, 0xff
    buffer_store_dwordx4 v[108:111], v100, s[44:47], s48 offen sc1
    s_mov_b64 exec, -1
L_fm_noini:
    v_lshrrev_b32 v5, 4, v1
    s_lshl_b32 s26, s2, 5
    s_lshl_b32 s27, s24, 2
    s_add_u32 s26, s26, s27
    v_add_u32 v5, s26, v5
    s_movk_i32 s27, 1280
    v_mul_lo_u32 v4, v5, s27
    v_and_b32 v5, 15, v1
    v_lshl_add_u32 v4, v5, 4, v4
    buffer_load_dwordx4 v[16:19], v4, s[8:11], 0 offen offset:0
    buffer_load_dwordx4 v[20:23], v4, s[8:11], 0 offen offset:256
    buffer_load_dwordx4 v[24:27], v4, s[8:11], 0 offen offset:512
    buffer_load_dwordx4 v[28:31], v4, s[8:11], 0 offen offset:768
    buffer_load_dwordx4 v[32:35], v4, s[8:11], 0 offen offset:1024
    v_mul_u32_u24 v4, 544, v5
    v_lshrrev_b32 v5, 4, v1
    v_lshl_add_u32 v4, v5, 3, v4
    s_lshl_b32 s27, s24, 5
    s_add_u32 s27, s27, 0
    v_add_u32 v4, s27, v4
    v_lshlrev_b32 v12, 3, v5
    s_lshl_b32 s27, s24, 5
    s_add_u32 s27, s27, 43520
    v_add_u32 v12, s27, v12
    v_mov_b32 v6, 0x3f803f80
    v_mov_b32 v8, 0
    v_mov_b32 v9, 0
    v_mov_b32 v10, 0
    v_mov_b32 v11, 0
    s_waitcnt vmcnt(0)
    ds_write_b64 v4, v[16:17] offset:0
    v_dot2_f32_bf16 v8, v16, v6, v8
    v_dot2_f32_bf16 v10, v16, v16, v10
    v_dot2_f32_bf16 v9, v17, v6, v9
    v_dot2_f32_bf16 v11, v17, v17, v11
    ds_write_b64 v4, v[18:19] offset:272
    v_dot2_f32_bf16 v8, v18, v6, v8
    v_dot2_f32_bf16 v10, v18, v18, v10
    v_dot2_f32_bf16 v9, v19, v6, v9
    v_dot2_f32_bf16 v11, v19, v19, v11
    ds_write_b64 v4, v[20:21] offset:8704
    v_dot2_f32_bf16 v8, v20, v6, v8
    v_dot2_f32_bf16 v10, v20, v20, v10
    v_dot2_f32_bf16 v9, v21, v6, v9
    v_dot2_f32_bf16 v11, v21, v21, v11
    ds_write_b64 v4, v[22:23] offset:8976
    v_dot2_f32_bf16 v8, v22, v6, v8
    v_dot2_f32_bf16 v10, v22, v22, v10
    v_dot2_f32_bf16 v9, v23, v6, v9
    v_dot2_f32_bf16 v11, v23, v23, v11
    ds_write_b64 v4, v[24:25] offset:17408
    v_dot2_f32_bf16 v8, v24, v6, v8
    v_dot2_f32_bf16 v10, v24, v24, v10
    v_dot2_f32_bf16 v9, v25, v6, v9
    v_dot2_f32_bf16 v11, v25, v25, v11
    ds_write_b64 v4, v[26:27] offset:17680
    v_dot2_f32_bf16 v8, v26, v6, v8
    v_dot2_f32_bf16 v10, v26, v26, v10
    v_dot2_f32_bf16 v9, v27, v6, v9
    v_dot2_f32_bf16 v11, v27, v27, v11
    ds_write_b64 v4, v[28:29] offset:26112
    v_dot2_f32_bf16 v8, v28, v6, v8
    v_dot2_f32_bf16 v10, v28, v28, v10
    v_dot2_f32_bf16 v9, v29, v6, v9
    v_dot2_f32_bf16 v11, v29, v29, v11
    ds_write_b64 v4, v[30:31] offset:26384
    v_dot2_f32_bf16 v8, v30, v6, v8
    v_dot2_f32_bf16 v10, v30, v30, v10
    v_dot2_f32_bf16 v9, v31, v6, v9
    v_dot2_f32_bf16 v11, v31, v31, v11
    ds_write_b64 v4, v[32:33] offset:34816
    v_dot2_f32_bf16 v8, v32, v6, v8
    v_dot2_f32_bf16 v10, v32, v32, v10
    v_dot2_f32_bf16 v9, v33, v6, v9
    v_dot2_f32_bf16 v11, v33, v33, v11
    ds_write_b64 v4, v[34:35] offset:35088
    v_dot2_f32_bf16 v8, v34, v6, v8
    v_dot2_f32_bf16 v10, v34, v34, v10
    v_dot2_f32_bf16 v9, v35, v6, v9
    v_dot2_f32_bf16 v11, v35, v35, v11
    s_nop 1
    v_add_f32 v8, v8, v9
    v_add_f32 v10, v10, v11
    s_nop 0
    v_add_f32_dpp v8, v8, v8 row_ror:1 row_mask:0xf bank_mask:0xf
    s_nop 1
    v_add_f32_dpp v8, v8, v8 row_ror:2 row_mask:0xf bank_mask:0xf
    s_nop 1
    v_add_f32_dpp v8, v8, v8 row_ror:4 row_mask:0xf bank_mask:0xf
    s_nop 1
    v_add_f32_dpp v8, v8, v8 row_ror:8 row_mask:0xf bank_mask:0xf
    v_add_f32_dpp v10, v10, v10 row_ror:1 row_mask:0xf bank_mask:0xf
    s_nop 1
    v_add_f32_dpp v10, v10, v10 row_ror:2 row_mask:0xf bank_mask:0xf
    s_nop 1
    v_add_f32_dpp v10, v10, v10 row_ror:4 row_mask:0xf bank_mask:0xf
    s_nop 1
    v_add_f32_dpp v10, v10, v10 row_ror:8 row_mask:0xf bank_mask:0xf
    v_mul_f32 v8, 0x3acccccd, v8
    v_mul_f32 v10, 0x3acccccd, v10
    v_fma_f32 v10, -v8, v8, v10
    v_max_f32 v10, 0, v10
    v_cvt_pk_bf16_f32 v8, v8, v8
    v_lshlrev_b32 v8, 16, v8
    v_cvt_pk_bf16_f32 v10, v10, v10
    v_lshlrev_b32 v10, 16, v10
    v_add_f32 v10, 0x3727c5ac, v10
    v_cvt_pk_bf16_f32 v10, v10, v10
    v_lshlrev_b32 v10, 16, v10
    v_sqrt_f32 v10, v10
    s_nop 0
    v_cvt_pk_bf16_f32 v10, v10, v10
    v_lshlrev_b32 v10, 16, v10
    v_rcp_f32 v10, v10
    s_nop 0
    v_mov_b32 v9, v10
    v_and_b32 v5, 15, v1
    v_cmp_eq_u32 vcc, 0, v5
    s_nop 0
    s_and_saveexec_b64 s[28:29], vcc
    ds_write_b64 v12, v[8:9]
    s_mov_b64 exec, s[28:29]
    v_lshrrev_b32 v5, 4, v0
    v_mul_u32_u24 v4, 272, v5
    v_and_b32 v8, 15, v0
    v_lshl_add_u32 v4, v8, 4, v4
    v_add_u32 v4, 0, v4
    v_lshlrev_b32 v5, 14, v5
    v_lshl_add_u32 v5, v8, 4, v5
    s_lshl_b32 s26, s2, 8
    v_add_u32 v5, s26, v5
    s_waitcnt lgkmcnt(0)
    s_barrier
    ds_read_b128 v[16:19], v4 offset:0
    ds_read_b128 v[20:23], v4 offset:8704
    ds_read_b128 v[24:27], v4 offset:17408
    ds_read_b128 v[28:31], v4 offset:26112
    ds_read_b128 v[32:35], v4 offset:34816
    s_cmp_eq_u32 s24, 0
    s_cbranch_scc0 L_lnx4_nost
    v_lshlrev_b32 v12, 4, v1
    v_add_u32 v10, 43520, v12
    s_mov_b64 exec, 0xffff
    ds_read_b128 v[40:43], v10
    s_waitcnt lgkmcnt(0)
    s_lshl_b32 s27, s2, 8
    buffer_store_dwordx4 v[40:43], v12, s[16:19], s27 offen sc1
    s_mov_b64 exec, -1
L_lnx4_nost:
    s_mov_b32 s26, 0
    s_waitcnt lgkmcnt(4)
    buffer_store_dwordx4 v[16:19], v5, s[12:15], s26 offen sc1
    s_add_u32 s26, s26, 524288
    s_waitcnt lgkmcnt(3)
    buffer_store_dwordx4 v[20:23], v5, s[12:15], s26 offen sc1
    s_add_u32 s26, s26, 524288
    s_waitcnt lgkmcnt(2)
    buffer_store_dwordx4 v[24:27], v5, s[12:15], s26 offen sc1
    s_add_u32 s26, s26, 524288
    s_waitcnt lgkmcnt(1)
    buffer_store_dwordx4 v[28:31], v5, s[12:15], s26 offen sc1
    s_add_u32 s26, s26, 524288
    s_waitcnt lgkmcnt(0)
    buffer_store_dwordx4 v[32:35], v5, s[12:15], s26 offen sc1
    s_add_u32 s26, s26, 524288
    s_waitcnt vmcnt(0)
    s_barrier
    s_cmp_eq_u32 s24, 0
    s_cbranch_scc0 L_s1a_done
    v_mov_b32 v6, 0
    v_mov_b32 v8, 1
    s_mov_b64 exec, 1
    buffer_atomic_add v8, v6, s[76:79], 0 offen sc0 sc1
    s_waitcnt vmcnt(0)
    v_readfirstlane_b32 s30, v8
    s_nop 0
    s_cmp_eq_u32 s30, 63
    s_cbranch_scc0 L_s1a_notlast
    v_mov_b32 v8, 1
    buffer_store_dword v8, v6, s[76:79], 0 offen offset:128 sc1
L_s1a_notlast:
    s_mov_b64 exec, -1
L_s1a_done:
    s_barrier
    s_mov_b32 s25, s2
    s_branch L_fm_repack
L_fm_kg:
    s_sub_u32 s36, s2, 64
    s_and_b32 s37, s36, 7
    s_mul_i32 s37, s37, 20
    s_lshr_b32 s36, s36, 3
    s_add_u32 s36, s36, s37
    s_load_dwordx4 s[40:43], s[0:1], 8
    s_load_dwordx4 s[44:47], s[0:1], 24
    s_load_dwordx4 s[48:51], s[0:1], 40
    s_load_dwordx2 s[52:53], s[0:1], 56
    s_load_dwordx2 s[54:55], s[0:1], 64
    s_and_b32 s25, s24, 3
    s_lshr_b32 s26, s24, 2
    s_lshl_b32 s27, s36, 2
    s_add_u32 s27, s27, s25
    s_mul_i32 s28, s24, 17408
    s_waitcnt lgkmcnt(0)
    s_lshl_b32 s30, s27, 8
    s_lshl_b32 s31, s26, 7
    s_add_u32 s30, s30, s31
    v_lshlrev_b32 v2, 1, v1
    v_add_u32 v2, s30, v2
    s_lshl_b32 s30, s27, 1
    v_mov_b32 v3, s30
    global_load_ushort v4, v2, s[40:41]
    global_load_ushort v5, v2, s[42:43]
    global_load_ushort v6, v2, s[44:45]
    global_load_ushort v7, v2, s[46:47]
    global_load_ushort v8, v2, s[48:49]
    global_load_ushort v9, v2, s[50:51]
    global_load_ushort v10, v3, s[52:53]
    s_lshl_b32 s30, s27, 1
    v_mov_b32 v108, s30
    global_load_ushort v109, v108, s[54:55]
    s_load_dwordx2 s[76:77], s[0:1], 112
    s_waitcnt lgkmcnt(0)
    s_mov_b32 s78, 256
    s_mov_b32 s79, 131072
    s_add_u32 s8, s6, 21069824
    s_addc_u32 s9, s7, 0
    s_mov_b32 s10, 16384
    s_mov_b32 s11, 131072
    s_mov_b32 s12, s6
    s_mov_b32 s13, s7
    s_mov_b32 s14, 2621440
    s_mov_b32 s15, 131072
    s_add_u32 s16, s6, 6291456
    s_addc_u32 s17, s7, 0
    s_mov_b32 s18, 2621440
    s_mov_b32 s19, 131072
    v_lshrrev_b32 v45, 2, v1
    v_mul_u32_u24 v45, 272, v45
    v_and_b32 v46, 3, v1
    v_lshl_add_u32 v45, v46, 2, v45
    v_add_u32 v45, s28, v45
    v_lshrrev_b32 v46, 4, v1
    v_mul_u32_u24 v46, 272, v46
    v_and_b32 v44, 15, v1
    v_lshl_add_u32 v46, v44, 4, v46
    v_add_u32 v46, s28, v46
    s_waitcnt vmcnt(0)
    v_lshlrev_b32 v4, 16, v4
    v_lshlrev_b32 v5, 16, v5
    v_lshlrev_b32 v6, 16, v6
    v_lshlrev_b32 v7, 16, v7
    v_lshlrev_b32 v8, 16, v8
    v_lshlrev_b32 v9, 16, v9
    v_lshlrev_b32 v10, 16, v10
    v_mul_f32 v48, 0x3fb8aa3b, v10
    v_mov_b32 v49, 0x3fb8aa3b
    v_fma_f32 v49, v10, v49, -v48
    v_mov_b32 v50, 0x32a57060
    v_fmac_f32 v49, v10, v50
    v_exp_f32 v48, v48
    v_mul_f32 v49, 0x3f317218, v49
    v_fma_f32 v50, v48, v49, v48
    v_cvt_pk_bf16_f32 v50, v50, v50
    v_lshlrev_b32 v50, 16, v50
    v_mul_f32 v4, v50, v4
    v_mul_f32 v5, v50, v5
    v_mul_f32 v6, v50, v6
    v_mul_f32 v7, v50, v7
    v_mul_f32 v51, 0x3fb8aa3b, v4
    v_mul_f32 v54, 0x3e22f983, v5
    v_mul_f32 v48, v9, v7
    v_mul_f32 v49, v9, v6
    v_fma_f32 v12, v8, v6, -v48
    v_fma_f32 v13, v8, v7, v49
    v_mov_b32 v52, v51
    v_mov_b32 v53, v54
    v_exp_f32 v52, v52
    v_fract_f32 v53, v53
    v_cos_f32 v14, v53
    v_sin_f32 v15, v53
    v_mul_f32 v14, v14, v52
    v_mul_f32 v15, v15, v52
    v_mul_f32 v52, 0x41000000, v51
    v_mul_f32 v53, 0x41000000, v54
    v_exp_f32 v52, v52
    v_fract_f32 v53, v53
    v_cos_f32 v16, v53
    v_sin_f32 v17, v53
    v_mul_f32 v16, v16, v52
    v_mul_f32 v17, v17, v52
    v_mul_f32 v52, 0x43000000, v51
    v_mul_f32 v53, 0x43000000, v54
    v_exp_f32 v52, v52
    v_fract_f32 v53, v53
    v_cos_f32 v18, v53
    v_sin_f32 v19, v53
    v_mul_f32 v18, v18, v52
    v_mul_f32 v19, v19, v52
    v_mov_b32 v28, v12
    v_mov_b32 v29, v13
    v_cvt_pk_bf16_f32 v44, v28, -v29
    ds_write_b32 v45, v44 offset:4352
    v_mov_b32 v22, 1.0
    v_mov_b32 v23, 0
    v_cvt_pk_bf16_f32 v44, v22, v23
    ds_write_b32 v45, v44 offset:0
    v_pk_mul_f32 v[20:21], v[28:29], v[14:15] op_sel:[0,0] op_sel_hi:[0,1]
    v_pk_fma_f32 v[30:31], v[28:29], v[14:15], v[20:21] op_sel:[1,1,0] op_sel_hi:[1,0,1] neg_lo:[0,1,0]
    v_cvt_pk_bf16_f32 v47, v30, -v31
    ds_write_b32 v45, v47 offset:4368
    v_mov_b32 v22, v16
    v_mov_b32 v23, v17
    v_cvt_pk_bf16_f32 v47, v22, v23
    ds_write_b32 v45, v47 offset:16
    v_pk_mul_f32 v[20:21], v[30:31], v[14:15] op_sel:[0,0] op_sel_hi:[0,1]
    v_pk_fma_f32 v[32:33], v[30:31], v[14:15], v[20:21] op_sel:[1,1,0] op_sel_hi:[1,0,1] neg_lo:[0,1,0]
    v_cvt_pk_bf16_f32 v44, v32, -v33
    ds_write_b32 v45, v44 offset:4384
    v_pk_mul_f32 v[20:21], v[22:23], v[16:17] op_sel:[0,0] op_sel_hi:[0,1]
    v_pk_fma_f32 v[22:23], v[22:23], v[16:17], v[20:21] op_sel:[1,1,0] op_sel_hi:[1,0,1] neg_lo:[0,1,0]
    v_cvt_pk_bf16_f32 v44, v22, v23
    ds_write_b32 v45, v44 offset:32
    v_pk_mul_f32 v[20:21], v[32:33], v[14:15] op_sel:[0,0] op_sel_hi:[0,1]
    v_pk_fma_f32 v[34:35], v[32:33], v[14:15], v[20:21] op_sel:[1,1,0] op_sel_hi:[1,0,1] neg_lo:[0,1,0]
    v_cvt_pk_bf16_f32 v47, v34, -v35
    ds_write_b32 v45, v47 offset:4400
    v_pk_mul_f32 v[20:21], v[22:23], v[16:17] op_sel:[0,0] op_sel_hi:[0,1]
    v_pk_fma_f32 v[22:23], v[22:23], v[16:17], v[20:21] op_sel:[1,1,0] op_sel_hi:[1,0,1] neg_lo:[0,1,0]
    v_cvt_pk_bf16_f32 v47, v22, v23
    ds_write_b32 v45, v47 offset:48
    v_pk_mul_f32 v[20:21], v[34:35], v[14:15] op_sel:[0,0] op_sel_hi:[0,1]
    v_pk_fma_f32 v[36:37], v[34:35], v[14:15], v[20:21] op_sel:[1,1,0] op_sel_hi:[1,0,1] neg_lo:[0,1,0]
    v_cvt_pk_bf16_f32 v44, v36, -v37
    ds_write_b32 v45, v44 offset:4416
    v_pk_mul_f32 v[20:21], v[22:23], v[16:17] op_sel:[0,0] op_sel_hi:[0,1]
    v_pk_fma_f32 v[22:23], v[22:23], v[16:17], v[20:21] op_sel:[1,1,0] op_sel_hi:[1,0,1] neg_lo:[0,1,0]
    v_cvt_pk_bf16_f32 v44, v22, v23
    ds_write_b32 v45, v44 offset:64
    v_pk_mul_f32 v[20:21], v[36:37], v[14:15] op_sel:[0,0] op_sel_hi:[0,1]
    v_pk_fma_f32 v[38:39], v[36:37], v[14:15], v[20:21] op_sel:[1,1,0] op_sel_hi:[1,0,1] neg_lo:[0,1,0]
    v_cvt_pk_bf16_f32 v47, v38, -v39
    ds_write_b32 v45, v47 offset:4432
    v_pk_mul_f32 v[20:21], v[22:23], v[16:17] op_sel:[0,0] op_sel_hi:[0,1]
    v_pk_fma_f32 v[22:23], v[22:23], v[16:17], v[20:21] op_sel:[1,1,0] op_sel_hi:[1,0,1] neg_lo:[0,1,0]
    v_cvt_pk_bf16_f32 v47, v22, v23
    ds_write_b32 v45, v47 offset:80
    v_pk_mul_f32 v[20:21], v[38:39], v[14:15] op_sel:[0,0] op_sel_hi:[0,1]
    v_pk_fma_f32 v[40:41], v[38:39], v[14:15], v[20:21] op_sel:[1,1,0] op_sel_hi:[1,0,1] neg_lo:[0,1,0]
    v_cvt_pk_bf16_f32 v44, v40, -v41
    ds_write_b32 v45, v44 offset:4448
    v_pk_mul_f32 v[20:21], v[22:23], v[16:17] op_sel:[0,0] op_sel_hi:[0,1]
    v_pk_fma_f32 v[22:23], v[22:23], v[16:17], v[20:21] op_sel:[1,1,0] op_sel_hi:[1,0,1] neg_lo:[0,1,0]
    v_cvt_pk_bf16_f32 v44, v22, v23
    ds_write_b32 v45, v44 offset:96
    v_pk_mul_f32 v[20:21], v[40:41], v[14:15] op_sel:[0,0] op_sel_hi:[0,1]
    v_pk_fma_f32 v[42:43], v[40:41], v[14:15], v[20:21] op_sel:[1,1,0] op_sel_hi:[1,0,1] neg_lo:[0,1,0]
    v_cvt_pk_bf16_f32 v47, v42, -v43
    ds_write_b32 v45, v47 offset:4464
    v_pk_mul_f32 v[20:21], v[22:23], v[16:17] op_sel:[0,0] op_sel_hi:[0,1]
    v_pk_fma_f32 v[22:23], v[22:23], v[16:17], v[20:21] op_sel:[1,1,0] op_sel_hi:[1,0,1] neg_lo:[0,1,0]
    v_cvt_pk_bf16_f32 v47, v22, v23
    ds_write_b32 v45, v47 offset:112
    v_pk_mul_f32 v[20:21], v[28:29], v[18:19] op_sel:[0,0] op_sel_hi:[0,1]
    v_pk_fma_f32 v[28:29], v[28:29], v[18:19], v[20:21] op_sel:[1,1,0] op_sel_hi:[1,0,1] neg_lo:[0,1,0]
    v_cvt_pk_bf16_f32 v44, v28, -v29
    ds_write_b32 v45, v44 offset:4480
    v_pk_mul_f32 v[20:21], v[22:23], v[16:17] op_sel:[0,0] op_sel_hi:[0,1]
    v_pk_fma_f32 v[22:23], v[22:23], v[16:17], v[20:21] op_sel:[1,1,0] op_sel_hi:[1,0,1] neg_lo:[0,1,0]
    v_cvt_pk_bf16_f32 v44, v22, v23
    ds_write_b32 v45, v44 offset:128
    v_pk_mul_f32 v[20:21], v[30:31], v[18:19] op_sel:[0,0] op_sel_hi:[0,1]
    v_pk_fma_f32 v[30:31], v[30:31], v[18:19], v[20:21] op_sel:[1,1,0] op_sel_hi:[1,0,1] neg_lo:[0,1,0]
    v_cvt_pk_bf16_f32 v47, v30, -v31
    ds_write_b32 v45, v47 offset:4496
    v_pk_mul_f32 v[20:21], v[22:23], v[16:17] op_sel:[0,0] op_sel_hi:[0,1]
    v_pk_fma_f32 v[22:23], v[22:23], v[16:17], v[20:21] op_sel:[1,1,0] op_sel_hi:[1,0,1] neg_lo:[0,1,0]
    v_cvt_pk_bf16_f32 v47, v22, v23
    ds_write_b32 v45, v47 offset:144
    v_pk_mul_f32 v[20:21], v[32:33], v[18:19] op_sel:[0,0] op_sel_hi:[0,1]
    v_pk_fma_f32 v[32:33], v[32:33], v[18:19], v[20:21] op_sel:[1,1,0] op_sel_hi:[1,0,1] neg_lo:[0,1,0]
    v_cvt_pk_bf16_f32 v44, v32, -v33
    ds_write_b32 v45, v44 offset:4512
    v_pk_mul_f32 v[20:21], v[22:23], v[16:17] op_sel:[0,0] op_sel_hi:[0,1]
    v_pk_fma_f32 v[22:23], v[22:23], v[16:17], v[20:21] op_sel:[1,1,0] op_sel_hi:[1,0,1] neg_lo:[0,1,0]
    v_cvt_pk_bf16_f32 v44, v22, v23
    ds_write_b32 v45, v44 offset:160
    v_pk_mul_f32 v[20:21], v[34:35], v[18:19] op_sel:[0,0] op_sel_hi:[0,1]
    v_pk_fma_f32 v[34:35], v[34:35], v[18:19], v[20:21] op_sel:[1,1,0] op_sel_hi:[1,0,1] neg_lo:[0,1,0]
    v_cvt_pk_bf16_f32 v47, v34, -v35
    ds_write_b32 v45, v47 offset:4528
    v_pk_mul_f32 v[20:21], v[22:23], v[16:17] op_sel:[0,0] op_sel_hi:[0,1]
    v_pk_fma_f32 v[22:23], v[22:23], v[16:17], v[20:21] op_sel:[1,1,0] op_sel_hi:[1,0,1] neg_lo:[0,1,0]
    v_cvt_pk_bf16_f32 v47, v22, v23
    ds_write_b32 v45, v47 offset:176
    v_pk_mul_f32 v[20:21], v[36:37], v[18:19] op_sel:[0,0] op_sel_hi:[0,1]
    v_pk_fma_f32 v[36:37], v[36:37], v[18:19], v[20:21] op_sel:[1,1,0] op_sel_hi:[1,0,1] neg_lo:[0,1,0]
    v_cvt_pk_bf16_f32 v44, v36, -v37
    ds_write_b32 v45, v44 offset:4544
    v_pk_mul_f32 v[20:21], v[22:23], v[16:17] op_sel:[0,0] op_sel_hi:[0,1]
    v_pk_fma_f32 v[22:23], v[22:23], v[16:17], v[20:21] op_sel:[1,1,0] op_sel_hi:[1,0,1] neg_lo:[0,1,0]
    v_cvt_pk_bf16_f32 v44, v22, v23
    ds_write_b32 v45, v44 offset:192
    v_pk_mul_f32 v[20:21], v[38:39], v[18:19] op_sel:[0,0] op_sel_hi:[0,1]
    v_pk_fma_f32 v[38:39], v[38:39], v[18:19], v[20:21] op_sel:[1,1,0] op_sel_hi:[1,0,1] neg_lo:[0,1,0]
    v_cvt_pk_bf16_f32 v47, v38, -v39
    ds_write_b32 v45, v47 offset:4560
    v_pk_mul_f32 v[20:21], v[22:23], v[16:17] op_sel:[0,0] op_sel_hi:[0,1]
    v_pk_fma_f32 v[22:23], v[22:23], v[16:17], v[20:21] op_sel:[1,1,0] op_sel_hi:[1,0,1] neg_lo:[0,1,0]
    v_cvt_pk_bf16_f32 v47, v22, v23
    ds_write_b32 v45, v47 offset:208
    v_pk_mul_f32 v[20:21], v[40:41], v[18:19] op_sel:[0,0] op_sel_hi:[0,1]
    v_pk_fma_f32 v[40:41], v[40:41], v[18:19], v[20:21] op_sel:[1,1,0] op_sel_hi:[1,0,1] neg_lo:[0,1,0]
    v_cvt_pk_bf16_f32 v44, v40, -v41
    ds_write_b32 v45, v44 offset:4576
    v_pk_mul_f32 v[20:21], v[22:23], v[16:17] op_sel:[0,0] op_sel_hi:[0,1]
    v_pk_fma_f32 v[22:23], v[22:23], v[16:17], v[20:21] op_sel:[1,1,0] op_sel_hi:[1,0,1] neg_lo:[0,1,0]
    v_cvt_pk_bf16_f32 v44, v22, v23
    ds_write_b32 v45, v44 offset:224
    v_pk_mul_f32 v[20:21], v[42:43], v[18:19] op_sel:[0,0] op_sel_hi:[0,1]
    v_pk_fma_f32 v[42:43], v[42:43], v[18:19], v[20:21] op_sel:[1,1,0] op_sel_hi:[1,0,1] neg_lo:[0,1,0]
    v_cvt_pk_bf16_f32 v47, v42, -v43
    ds_write_b32 v45, v47 offset:4592
    v_pk_mul_f32 v[20:21], v[22:23], v[16:17] op_sel:[0,0] op_sel_hi:[0,1]
    v_pk_fma_f32 v[22:23], v[22:23], v[16:17], v[20:21] op_sel:[1,1,0] op_sel_hi:[1,0,1] neg_lo:[0,1,0]
    v_cvt_pk_bf16_f32 v47, v22, v23
    ds_write_b32 v45, v47 offset:240
    v_pk_mul_f32 v[20:21], v[28:29], v[18:19] op_sel:[0,0] op_sel_hi:[0,1]
    v_pk_fma_f32 v[28:29], v[28:29], v[18:19], v[20:21] op_sel:[1,1,0] op_sel_hi:[1,0,1] neg_lo:[0,1,0]
    v_cvt_pk_bf16_f32 v44, v28, -v29
    ds_write_b32 v45, v44 offset:8704
    v_pk_mul_f32 v[20:21], v[32:33], v[18:19] op_sel:[0,0] op_sel_hi:[0,1]
    v_pk_fma_f32 v[32:33], v[32:33], v[18:19], v[20:21] op_sel:[1,1,0] op_sel_hi:[1,0,1] neg_lo:[0,1,0]
    v_cvt_pk_bf16_f32 v47, v32, -v33
    ds_write_b32 v45, v47 offset:8720
    v_pk_mul_f32 v[20:21], v[36:37], v[18:19] op_sel:[0,0] op_sel_hi:[0,1]
    v_pk_fma_f32 v[36:37], v[36:37], v[18:19], v[20:21] op_sel:[1,1,0] op_sel_hi:[1,0,1] neg_lo:[0,1,0]
    v_cvt_pk_bf16_f32 v44, v36, -v37
    ds_write_b32 v45, v44 offset:8736
    v_pk_mul_f32 v[20:21], v[40:41], v[18:19] op_sel:[0,0] op_sel_hi:[0,1]
    v_pk_fma_f32 v[40:41], v[40:41], v[18:19], v[20:21] op_sel:[1,1,0] op_sel_hi:[1,0,1] neg_lo:[0,1,0]
    v_cvt_pk_bf16_f32 v47, v40, -v41
    ds_write_b32 v45, v47 offset:8752
    v_pk_mul_f32 v[20:21], v[28:29], v[18:19] op_sel:[0,0] op_sel_hi:[0,1]
    v_pk_fma_f32 v[28:29], v[28:29], v[18:19], v[20:21] op_sel:[1,1,0] op_sel_hi:[1,0,1] neg_lo:[0,1,0]
    v_cvt_pk_bf16_f32 v44, v28, -v29
    ds_write_b32 v45, v44 offset:8768
    v_pk_mul_f32 v[20:21], v[32:33], v[18:19] op_sel:[0,0] op_sel_hi:[0,1]
    v_pk_fma_f32 v[32:33], v[32:33], v[18:19], v[20:21] op_sel:[1,1,0] op_sel_hi:[1,0,1] neg_lo:[0,1,0]
    v_cvt_pk_bf16_f32 v47, v32, -v33
    ds_write_b32 v45, v47 offset:8784
    v_pk_mul_f32 v[20:21], v[36:37], v[18:19] op_sel:[0,0] op_sel_hi:[0,1]
    v_pk_fma_f32 v[36:37], v[36:37], v[18:19], v[20:21] op_sel:[1,1,0] op_sel_hi:[1,0,1] neg_lo:[0,1,0]
    v_cvt_pk_bf16_f32 v44, v36, -v37
    ds_write_b32 v45, v44 offset:8800
    v_pk_mul_f32 v[20:21], v[40:41], v[18:19] op_sel:[0,0] op_sel_hi:[0,1]
    v_pk_fma_f32 v[40:41], v[40:41], v[18:19], v[20:21] op_sel:[1,1,0] op_sel_hi:[1,0,1] neg_lo:[0,1,0]
    v_cvt_pk_bf16_f32 v47, v40, -v41
    ds_write_b32 v45, v47 offset:8816
    v_pk_mul_f32 v[20:21], v[28:29], v[18:19] op_sel:[0,0] op_sel_hi:[0,1]
    v_pk_fma_f32 v[24:25], v[28:29], v[18:19], v[20:21] op_sel:[1,1,0] op_sel_hi:[1,0,1] neg_lo:[0,1,0]
    v_cvt_pk_bf16_f32 v44, v24, -v25
    ds_write_b32 v45, v44 offset:8832
    v_cvt_pk_bf16_f32 v44, v24, -v25
    ds_write_b32 v45, v44 offset:13056
    v_pk_mul_f32 v[20:21], v[36:37], v[18:19] op_sel:[0,0] op_sel_hi:[0,1]
    v_pk_fma_f32 v[26:27], v[36:37], v[18:19], v[20:21] op_sel:[1,1,0] op_sel_hi:[1,0,1] neg_lo:[0,1,0]
    v_cvt_pk_bf16_f32 v47, v26, -v27
    ds_write_b32 v45, v47 offset:13072
    v_pk_mul_f32 v[20:21], v[24:25], v[18:19] op_sel:[0,0] op_sel_hi:[0,1]
    v_pk_fma_f32 v[24:25], v[24:25], v[18:19], v[20:21] op_sel:[1,1,0] op_sel_hi:[1,0,1] neg_lo:[0,1,0]
    v_cvt_pk_bf16_f32 v44, v24, -v25
    ds_write_b32 v45, v44 offset:13120
    v_pk_mul_f32 v[20:21], v[26:27], v[18:19] op_sel:[0,0] op_sel_hi:[0,1]
    v_pk_fma_f32 v[26:27], v[26:27], v[18:19], v[20:21] op_sel:[1,1,0] op_sel_hi:[1,0,1] neg_lo:[0,1,0]
    v_cvt_pk_bf16_f32 v47, v26, -v27
    ds_write_b32 v45, v47 offset:13136
    v_pk_mul_f32 v[20:21], v[24:25], v[18:19] op_sel:[0,0] op_sel_hi:[0,1]
    v_pk_fma_f32 v[24:25], v[24:25], v[18:19], v[20:21] op_sel:[1,1,0] op_sel_hi:[1,0,1] neg_lo:[0,1,0]
    v_cvt_pk_bf16_f32 v44, v24, -v25
    ds_write_b32 v45, v44 offset:13184
    v_pk_mul_f32 v[20:21], v[26:27], v[18:19] op_sel:[0,0] op_sel_hi:[0,1]
    v_pk_fma_f32 v[26:27], v[26:27], v[18:19], v[20:21] op_sel:[1,1,0] op_sel_hi:[1,0,1] neg_lo:[0,1,0]
    v_cvt_pk_bf16_f32 v47, v26, -v27
    ds_write_b32 v45, v47 offset:13200
    v_pk_mul_f32 v[20:21], v[24:25], v[18:19] op_sel:[0,0] op_sel_hi:[0,1]
    v_pk_fma_f32 v[24:25], v[24:25], v[18:19], v[20:21] op_sel:[1,1,0] op_sel_hi:[1,0,1] neg_lo:[0,1,0]
    v_cvt_pk_bf16_f32 v44, v24, -v25
    ds_write_b32 v45, v44 offset:13248
    v_pk_mul_f32 v[20:21], v[26:27], v[18:19] op_sel:[0,0] op_sel_hi:[0,1]
    v_pk_fma_f32 v[26:27], v[26:27], v[18:19], v[20:21] op_sel:[1,1,0] op_sel_hi:[1,0,1] neg_lo:[0,1,0]
    v_cvt_pk_bf16_f32 v47, v26, -v27
    ds_write_b32 v45, v47 offset:13264
    v_pk_mul_f32 v[20:21], v[24:25], v[18:19] op_sel:[0,0] op_sel_hi:[0,1]
    v_pk_fma_f32 v[24:25], v[24:25], v[18:19], v[20:21] op_sel:[1,1,0] op_sel_hi:[1,0,1] neg_lo:[0,1,0]
    v_cvt_pk_bf16_f32 v44, v24, -v25
    ds_write_b32 v45, v44 offset:13088
    v_pk_mul_f32 v[20:21], v[24:25], v[18:19] op_sel:[0,0] op_sel_hi:[0,1]
    v_pk_fma_f32 v[24:25], v[24:25], v[18:19], v[20:21] op_sel:[1,1,0] op_sel_hi:[1,0,1] neg_lo:[0,1,0]
    v_cvt_pk_bf16_f32 v44, v24, -v25
    ds_write_b32 v45, v44 offset:13152
    v_pk_mul_f32 v[20:21], v[24:25], v[18:19] op_sel:[0,0] op_sel_hi:[0,1]
    v_pk_fma_f32 v[24:25], v[24:25], v[18:19], v[20:21] op_sel:[1,1,0] op_sel_hi:[1,0,1] neg_lo:[0,1,0]
    v_cvt_pk_bf16_f32 v44, v24, -v25
    ds_write_b32 v45, v44 offset:13216
    v_pk_mul_f32 v[20:21], v[24:25], v[18:19] op_sel:[0,0] op_sel_hi:[0,1]
    v_pk_fma_f32 v[24:25], v[24:25], v[18:19], v[20:21] op_sel:[1,1,0] op_sel_hi:[1,0,1] neg_lo:[0,1,0]
    v_cvt_pk_bf16_f32 v44, v24, -v25
    ds_write_b32 v45, v44 offset:13280
    v_pk_mul_f32 v[20:21], v[24:25], v[18:19] op_sel:[0,0] op_sel_hi:[0,1]
    v_pk_fma_f32 v[24:25], v[24:25], v[18:19], v[20:21] op_sel:[1,1,0] op_sel_hi:[1,0,1] neg_lo:[0,1,0]
    v_cvt_pk_bf16_f32 v47, v24, -v25
    ds_write_b32 v45, v47 offset:13104
    v_pk_mul_f32 v[20:21], v[24:25], v[18:19] op_sel:[0,0] op_sel_hi:[0,1]
    v_pk_fma_f32 v[24:25], v[24:25], v[18:19], v[20:21] op_sel:[1,1,0] op_sel_hi:[1,0,1] neg_lo:[0,1,0]
    v_cvt_pk_bf16_f32 v47, v24, -v25
    ds_write_b32 v45, v47 offset:13168
    v_pk_mul_f32 v[20:21], v[24:25], v[18:19] op_sel:[0,0] op_sel_hi:[0,1]
    v_pk_fma_f32 v[24:25], v[24:25], v[18:19], v[20:21] op_sel:[1,1,0] op_sel_hi:[1,0,1] neg_lo:[0,1,0]
    v_cvt_pk_bf16_f32 v47, v24, -v25
    ds_write_b32 v45, v47 offset:13232
    v_pk_mul_f32 v[20:21], v[24:25], v[18:19] op_sel:[0,0] op_sel_hi:[0,1]
    v_pk_fma_f32 v[24:25], v[24:25], v[18:19], v[20:21] op_sel:[1,1,0] op_sel_hi:[1,0,1] neg_lo:[0,1,0]
    v_cvt_pk_bf16_f32 v47, v24, -v25
    ds_write_b32 v45, v47 offset:13296
    v_pk_mul_f32 v[20:21], v[24:25], v[18:19] op_sel:[0,0] op_sel_hi:[0,1]
    v_pk_fma_f32 v[24:25], v[24:25], v[18:19], v[20:21] op_sel:[1,1,0] op_sel_hi:[1,0,1] neg_lo:[0,1,0]
    v_cvt_pk_bf16_f32 v47, v24, -v25
    ds_write_b32 v45, v47 offset:8848
    v_mov_b32 v56, 0
    v_mov_b32 v57, 0
    v_mov_b32 v58, 0
    v_mov_b32 v59, 0
    v_mov_b32 v60, 0
    v_mov_b32 v61, 0
    v_mov_b32 v62, 0
    v_mov_b32 v63, 0
    v_mov_b32 v64, 0
    v_mov_b32 v65, 0
    v_mov_b32 v66, 0
    v_mov_b32 v67, 0
    s_waitcnt lgkmcnt(0)
    ds_read_b128 v[68:71], v46 offset:0
    ds_read_b128 v[72:75], v46 offset:4352
    ds_read_b128 v[76:79], v46 offset:8704
    ds_read_b128 v[80:83], v46 offset:13056
    s_waitcnt lgkmcnt(2)
    v_mfma_f32_16x16x32_bf16 v[56:59], v[72:75], v[68:71], v[56:59]
    s_waitcnt lgkmcnt(1)
    v_mfma_f32_16x16x32_bf16 v[60:63], v[76:79], v[68:71], v[60:63]
    s_waitcnt lgkmcnt(0)
    v_mfma_f32_16x16x32_bf16 v[64:67], v[80:83], v[68:71], v[64:67]
    ds_read_b128 v[68:71], v46 offset:1088
    ds_read_b128 v[72:75], v46 offset:5440
    ds_read_b128 v[76:79], v46 offset:9792
    ds_read_b128 v[80:83], v46 offset:14144
    s_waitcnt lgkmcnt(2)
    v_mfma_f32_16x16x32_bf16 v[56:59], v[72:75], v[68:71], v[56:59]
    s_waitcnt lgkmcnt(1)
    v_mfma_f32_16x16x32_bf16 v[60:63], v[76:79], v[68:71], v[60:63]
    s_waitcnt lgkmcnt(0)
    v_mfma_f32_16x16x32_bf16 v[64:67], v[80:83], v[68:71], v[64:67]
    ds_read_b128 v[68:71], v46 offset:2176
    ds_read_b128 v[72:75], v46 offset:6528
    ds_read_b128 v[76:79], v46 offset:10880
    ds_read_b128 v[80:83], v46 offset:15232
    s_waitcnt lgkmcnt(2)
    v_mfma_f32_16x16x32_bf16 v[56:59], v[72:75], v[68:71], v[56:59]
    s_waitcnt lgkmcnt(1)
    v_mfma_f32_16x16x32_bf16 v[60:63], v[76:79], v[68:71], v[60:63]
    s_waitcnt lgkmcnt(0)
    v_mfma_f32_16x16x32_bf16 v[64:67], v[80:83], v[68:71], v[64:67]
    ds_read_b128 v[68:71], v46 offset:3264
    ds_read_b128 v[72:75], v46 offset:7616
    ds_read_b128 v[76:79], v46 offset:11968
    ds_read_b128 v[80:83], v46 offset:16320
    s_waitcnt lgkmcnt(2)
    v_mfma_f32_16x16x32_bf16 v[56:59], v[72:75], v[68:71], v[56:59]
    s_waitcnt lgkmcnt(1)
    v_mfma_f32_16x16x32_bf16 v[60:63], v[76:79], v[68:71], v[60:63]
    s_waitcnt lgkmcnt(0)
    v_mfma_f32_16x16x32_bf16 v[64:67], v[80:83], v[68:71], v[64:67]
    s_mul_i32 s29, s25, 3072
    s_add_u32 s29, s29, 139264
    s_cmp_eq_u32 s26, 0
    s_cbranch_scc1 L_fm_h0
    v_lshlrev_b32 v44, 4, v1
    v_add_u32 v44, s29, v44
    ds_write_b128 v44, v[56:59] offset:0
    ds_write_b128 v44, v[60:63] offset:1024
    ds_write_b128 v44, v[64:67] offset:2048
    s_waitcnt lgkmcnt(0)
    s_barrier
    s_cmp_eq_u32 s24, 4
    s_cbranch_scc0 L_s1w_done_c
    v_mov_b32 v6, 0
    s_mov_b32 s30, 0
    s_mov_b64 exec, 1
L_s1w_poll_c:
    buffer_load_dword v8, v6, s[76:79], 0 offen offset:128 sc1
    s_waitcnt vmcnt(0)
    v_readfirstlane_b32 s31, v8
    s_nop 0
    s_cmp_lg_u32 s31, 0
    s_cbranch_scc1 L_s1w_ok_c
    s_add_u32 s30, s30, 1
    s_cmp_lt_u32 s30, 200000
    s_cbranch_scc1 L_s1w_poll_c
L_s1w_ok_c:
    s_mov_b64 exec, -1
L_s1w_done_c:
    s_branch L_fm_kdone
L_fm_h0:
    s_barrier
    v_mov_b32 v8, 0
    v_mov_b32 v9, 0
    v_mov_b32 v10, 0
    v_mov_b32 v11, 0
    v_lshlrev_b32 v3, 4, v0
    v_add_u32 v4, 16384, v3
    v_cmp_gt_u32 vcc, 64, v0
    s_nop 1
    v_cndmask_b32 v3, v4, v3, vcc
    v_cmp_gt_u32 vcc, 80, v0
    s_nop 0
    s_and_saveexec_b64 s[90:91], vcc
    s_cbranch_execz L_cv_nopad_m
    ds_write_b128 v3, v[8:11]
L_cv_nopad_m:
    s_mov_b64 exec, s[90:91]
    s_mul_i32 s31, s25, 5184
    s_add_u32 s31, s31, 51072
    v_lshlrev_b32 v2, 4, v1
    v_add_u32 v2, s31, v2
    v_lshrrev_b32 v3, 5, v1
    v_lshlrev_b32 v3, 8, v3
    v_and_b32 v104, 15, v1
    v_lshl_add_u32 v3, v104, 4, v3
    v_bfe_u32 v104, v1, 4, 1
    v_lshl_add_u32 v3, v104, 3, v3
    v_add_u32 v3, s31, v3
    v_mov_b32 v104, 0
    v_mov_b32 v105, 0
    v_mov_b32 v106, 0
    v_mov_b32 v107, 0
    v_lshlrev_b32 v44, 4, v1
    v_add_u32 v44, s29, v44
    ds_read_b128 v[68:71], v44 offset:0
    ds_read_b128 v[72:75], v44 offset:1024
    ds_read_b128 v[76:79], v44 offset:2048
    s_waitcnt lgkmcnt(0)
    v_add_f32 v56, v56, v68
    v_add_f32 v57, v57, v69
    v_add_f32 v58, v58, v70
    v_add_f32 v59, v59, v71
    v_add_f32 v60, v60, v72
    v_add_f32 v61, v61, v73
    v_add_f32 v62, v62, v74
    v_add_f32 v63, v63, v75
    v_add_f32 v64, v64, v76
    v_add_f32 v65, v65, v77
    v_add_f32 v66, v66, v78
    v_add_f32 v67, v67, v79
    v_cvt_pk_bf16_f32 v84, v56, v57
    v_cvt_pk_bf16_f32 v85, v58, v59
    s_mov_b64 exec, 0x3fffffff
    ds_write_b128 v2, v[104:107]
    s_mov_b64 exec, -1
    ds_write_b64 v3, v[84:85] offset:480
    v_mov_b32 v100, 0
    s_nop 1
    v_mov_b32_dpp v100, v60 wave_shl:1 row_mask:0xf bank_mask:0xf
    v_cvt_pk_bf16_f32 v88, v60, v60
    v_cvt_pk_bf16_f32 v89, v61, v62
    v_cvt_pk_bf16_f32 v90, v62, v62
    v_cvt_pk_bf16_f32 v91, v63, v100
    s_mov_b32 exec_hi, 0
    ds_write_b128 v2, v[88:91] offset:992
    s_mov_b64 exec, -1
    v_readlane_b32 s32, v66, 0
    s_nop 1
    v_mov_b32 v100, s32
    s_nop 1
    v_mov_b32_dpp v100, v64 wave_shl:1 row_mask:0xf bank_mask:0xf
    v_cvt_pk_bf16_f32 v92, v64, v64
    v_cvt_pk_bf16_f32 v93, v64, v65
    v_cvt_pk_bf16_f32 v94, v65, v65
    v_cvt_pk_bf16_f32 v95, v100, v100
    ds_write_b128 v2, v[92:95] offset:1504
    v_and_b32 v101, 1, v1
    v_cmp_eq_u32 vcc, 0, v101
    v_readlane_b32 s32, v67, 0
    s_nop 1
    v_mov_b32 v100, s32
    s_nop 1
    v_mov_b32_dpp v100, v66 wave_shl:1 row_mask:0xf bank_mask:0xf
    v_cvt_pk_bf16_f32 v96, v66, v66
    v_cndmask_b32 v101, v100, v66, vcc
    v_mov_b32 v97, v96
    v_cvt_pk_bf16_f32 v98, v101, v100
    v_cvt_pk_bf16_f32 v99, v100, v100
    ds_write_b128 v2, v[96:99] offset:2528
    v_readlane_b32 s32, v61, 32
    s_nop 1
    v_mov_b32 v100, s32
    s_nop 1
    v_mov_b32_dpp v100, v67 wave_shl:1 row_mask:0xf bank_mask:0xf
    v_cvt_pk_bf16_f32 v84, v67, v67
    v_cndmask_b32 v101, v100, v67, vcc
    v_mov_b32 v85, v84
    v_cvt_pk_bf16_f32 v86, v101, v100
    v_cvt_pk_bf16_f32 v87, v100, v100
    ds_write_b128 v2, v[84:87] offset:3552
L_fm_kdone:
    v_mov_b32 v30, v109
    s_waitcnt lgkmcnt(0)
    s_barrier
    v_lshlrev_b32 v2, 4, v0
    s_lshl_b32 s30, s36, 14
    s_add_u32 s31, s30, 8192
    buffer_load_dwordx4 v[110:113], v2, s[12:15], s30 offen sc1
    buffer_load_dwordx4 v[32:35], v2, s[8:11], 0 offen sc1
    buffer_load_dwordx4 v[114:117], v2, s[12:15], s31 offen sc1
    s_movk_i32 s30, 8192
    buffer_load_dwordx4 v[36:39], v2, s[8:11], s30 offen sc1
    v_add_u32 v4, 71808, v2
    v_add_u32 v3, 1024, v2
    s_waitcnt vmcnt(2)
    ds_write_b128 v4, v[110:113] offset:0
    v_lshlrev_b32 v48, 16, v110
    v_and_b32 v49, 0xffff0000, v110
    v_lshlrev_b32 v50, 16, v111
    v_and_b32 v51, 0xffff0000, v111
    v_lshlrev_b32 v56, 16, v112
    v_and_b32 v57, 0xffff0000, v112
    v_lshlrev_b32 v58, 16, v113
    v_and_b32 v59, 0xffff0000, v113
    v_pk_add_f32 v[48:49], v[48:49], v[32:33] op_sel_hi:[1,0] neg_lo:[0,1] neg_hi:[0,1]
    v_pk_add_f32 v[50:51], v[50:51], v[32:33] op_sel_hi:[1,0] neg_lo:[0,1] neg_hi:[0,1]
    v_pk_add_f32 v[56:57], v[56:57], v[34:35] op_sel_hi:[1,0] neg_lo:[0,1] neg_hi:[0,1]
    v_pk_add_f32 v[58:59], v[58:59], v[34:35] op_sel_hi:[1,0] neg_lo:[0,1] neg_hi:[0,1]
    v_cvt_pk_bf16_f32 v52, v48, v49
    v_cvt_pk_bf16_f32 v53, v50, v51
    v_cvt_pk_bf16_f32 v60, v56, v57
    v_cvt_pk_bf16_f32 v61, v58, v59
    v_lshlrev_b32 v48, 16, v52
    v_and_b32 v49, 0xffff0000, v52
    v_lshlrev_b32 v50, 16, v53
    v_and_b32 v51, 0xffff0000, v53
    v_lshlrev_b32 v56, 16, v60
    v_and_b32 v57, 0xffff0000, v60
    v_lshlrev_b32 v58, 16, v61
    v_and_b32 v59, 0xffff0000, v61
    v_pk_mul_f32 v[48:49], v[48:49], v[32:33] op_sel:[0,1] op_sel_hi:[1,1]
    v_pk_mul_f32 v[50:51], v[50:51], v[32:33] op_sel:[0,1] op_sel_hi:[1,1]
    v_pk_mul_f32 v[56:57], v[56:57], v[34:35] op_sel:[0,1] op_sel_hi:[1,1]
    v_pk_mul_f32 v[58:59], v[58:59], v[34:35] op_sel:[0,1] op_sel_hi:[1,1]
    v_cvt_pk_bf16_f32 v64, v48, v49
    v_cvt_pk_bf16_f32 v65, v50, v51
    v_cvt_pk_bf16_f32 v66, v56, v57
    v_cvt_pk_bf16_f32 v67, v58, v59
    ds_write_b128 v3, v[64:67] offset:0
    s_waitcnt vmcnt(0)
    ds_write_b128 v4, v[114:117] offset:8192
    v_lshlrev_b32 v72, 16, v114
    v_and_b32 v73, 0xffff0000, v114
    v_lshlrev_b32 v74, 16, v115
    v_and_b32 v75, 0xffff0000, v115
    v_lshlrev_b32 v80, 16, v116
    v_and_b32 v81, 0xffff0000, v116
    v_lshlrev_b32 v82, 16, v117
    v_and_b32 v83, 0xffff0000, v117
    v_pk_add_f32 v[72:73], v[72:73], v[36:37] op_sel_hi:[1,0] neg_lo:[0,1] neg_hi:[0,1]
    v_pk_add_f32 v[74:75], v[74:75], v[36:37] op_sel_hi:[1,0] neg_lo:[0,1] neg_hi:[0,1]
    v_pk_add_f32 v[80:81], v[80:81], v[38:39] op_sel_hi:[1,0] neg_lo:[0,1] neg_hi:[0,1]
    v_pk_add_f32 v[82:83], v[82:83], v[38:39] op_sel_hi:[1,0] neg_lo:[0,1] neg_hi:[0,1]
    v_cvt_pk_bf16_f32 v76, v72, v73
    v_cvt_pk_bf16_f32 v77, v74, v75
    v_cvt_pk_bf16_f32 v84, v80, v81
    v_cvt_pk_bf16_f32 v85, v82, v83
    v_lshlrev_b32 v72, 16, v76
    v_and_b32 v73, 0xffff0000, v76
    v_lshlrev_b32 v74, 16, v77
    v_and_b32 v75, 0xffff0000, v77
    v_lshlrev_b32 v80, 16, v84
    v_and_b32 v81, 0xffff0000, v84
    v_lshlrev_b32 v82, 16, v85
    v_and_b32 v83, 0xffff0000, v85
    v_pk_mul_f32 v[72:73], v[72:73], v[36:37] op_sel:[0,1] op_sel_hi:[1,1]
    v_pk_mul_f32 v[74:75], v[74:75], v[36:37] op_sel:[0,1] op_sel_hi:[1,1]
    v_pk_mul_f32 v[80:81], v[80:81], v[38:39] op_sel:[0,1] op_sel_hi:[1,1]
    v_pk_mul_f32 v[82:83], v[82:83], v[38:39] op_sel:[0,1] op_sel_hi:[1,1]
    v_cvt_pk_bf16_f32 v88, v72, v73
    v_cvt_pk_bf16_f32 v89, v74, v75
    v_cvt_pk_bf16_f32 v90, v80, v81
    v_cvt_pk_bf16_f32 v91, v82, v83
    ds_write_b128 v3, v[88:91] offset:8192
    s_waitcnt vmcnt(0) lgkmcnt(0)
    s_barrier
    v_lshrrev_b32 v5, 4, v1
    v_bfe_u32 v6, v1, 2, 2
    v_and_b32 v7, 3, v1
    v_lshlrev_b32 v3, 7, v5
    v_lshl_add_u32 v3, v7, 5, v3
    v_lshl_add_u32 v3, v6, 3, v3
    s_and_b32 s30, s24, 1
    s_lshr_b32 s31, s24, 1
    s_lshl_b32 s32, s30, 3
    s_lshl_b32 s33, s31, 9
    s_add_u32 s32, s32, s33
    s_sub_u32 s32, 3072, s32
    v_sub_u32 v3, s32, v3
    v_mul_u32_u24 v4, 8352, v7
    v_lshl_add_u32 v4, v5, 5, v4
    v_lshl_add_u32 v4, v6, 3, v4
    s_mul_i32 s32, s30, 4160
    s_lshl_b32 s33, s31, 7
    s_add_u32 s32, s32, s33
    s_add_u32 s32, s32, 17664
    v_add_u32 v4, s32, v4
    ds_read_b64_tr_b16 v[8:9], v3 offset:14336
    ds_read_b64_tr_b16 v[10:11], v3 offset:12288
    ds_read_b64_tr_b16 v[12:13], v3 offset:10240
    ds_read_b64_tr_b16 v[14:15], v3 offset:8192
    ds_read_b64_tr_b16 v[16:17], v3 offset:6144
    ds_read_b64_tr_b16 v[18:19], v3 offset:4096
    ds_read_b64_tr_b16 v[20:21], v3 offset:2048
    ds_read_b64_tr_b16 v[22:23], v3 offset:0
    v_subrev_u32 v5, 2048, v3
    s_cmp_lt_u32 s24, 2
    s_cbranch_scc0 L_cv_nolast_m
    ds_read_b64_tr_b16 v[24:25], v5
    s_waitcnt lgkmcnt(0)
    s_mov_b32 exec_hi, 0
    ds_write_b64 v4, v[24:25] offset:4096
    s_mov_b64 exec, -1
L_cv_nolast_m:
    s_waitcnt lgkmcnt(0)
    ds_write_b64 v4, v[8:9] offset:0
    ds_write_b64 v4, v[10:11] offset:512
    ds_write_b64 v4, v[12:13] offset:1024
    ds_write_b64 v4, v[14:15] offset:1536
    ds_write_b64 v4, v[16:17] offset:2048
    ds_write_b64 v4, v[18:19] offset:2560
    ds_write_b64 v4, v[20:21] offset:3072
    ds_write_b64 v4, v[22:23] offset:3584
    s_waitcnt lgkmcnt(0)
    s_barrier
    s_cmp_ge_u32 s24, 4
    s_cbranch_scc1 L_cv_fetch
    v_lshlrev_b32 v30, 16, v30
    v_and_b32 v5, 15, v1
    v_lshrrev_b32 v6, 4, v1
    v_and_b32 v7, 1, v5
    v_mul_u32_u24 v8, 4160, v7
    v_add_u32 v9, v5, v7
    v_lshlrev_b32 v9, 1, v9
    v_sub_u32 v8, v8, v9
    v_lshl_add_u32 v8, v6, 4, v8
    s_mul_i32 s30, s25, 8352
    s_add_u32 s30, s30, 21280
    v_add_u32 v16, s30, v8
    v_subrev_u32 v17, 512, v16
    v_subrev_u32 v18, 512, v17
    v_subrev_u32 v19, 512, v18
    v_subrev_u32 v20, 512, v19
    v_subrev_u32 v21, 512, v20
    v_subrev_u32 v22, 512, v21
    v_subrev_u32 v23, 512, v22
    v_lshlrev_b32 v24, 5, v5
    v_lshl_add_u32 v24, v6, 4, v24
    s_mul_i32 s30, s25, 5184
    s_add_u32 s30, s30, 51072
    v_add_u32 v24, s30, v24
    ds_read_b128 v[96:99], v24 offset:0
    ds_read2_b32 v[64:65], v16 offset0:0 offset1:1
    ds_read2_b32 v[66:67], v16 offset0:2 offset1:3
    ds_read_b128 v[100:103], v24 offset:512
    ds_read2_b32 v[68:69], v17 offset0:0 offset1:1
    ds_read2_b32 v[70:71], v17 offset0:2 offset1:3
    ds_read_b128 v[104:107], v24 offset:1024
    ds_read2_b32 v[72:73], v18 offset0:0 offset1:1
    ds_read2_b32 v[74:75], v18 offset0:2 offset1:3
    ds_read_b128 v[108:111], v24 offset:1536
    ds_read2_b32 v[76:77], v19 offset0:0 offset1:1
    ds_read2_b32 v[78:79], v19 offset0:2 offset1:3
    ds_read_b128 v[112:115], v24 offset:2048
    ds_read2_b32 v[80:81], v20 offset0:0 offset1:1
    ds_read2_b32 v[82:83], v20 offset0:2 offset1:3
    ds_read_b128 v[116:119], v24 offset:2560
    ds_read2_b32 v[84:85], v21 offset0:0 offset1:1
    ds_read2_b32 v[86:87], v21 offset0:2 offset1:3
    ds_read_b128 v[120:123], v24 offset:3072
    ds_read2_b32 v[88:89], v22 offset0:0 offset1:1
    ds_read2_b32 v[90:91], v22 offset0:2 offset1:3
    ds_read_b128 v[124:127], v24 offset:3584
    ds_read2_b32 v[92:93], v23 offset0:0 offset1:1
    ds_read2_b32 v[94:95], v23 offset0:2 offset1:3
    v_mov_b32 v32, 0
    v_mov_b32 v33, 0
    v_mov_b32 v34, 0
    v_mov_b32 v35, 0
    v_mov_b32 v36, 0
    v_mov_b32 v37, 0
    v_mov_b32 v38, 0
    v_mov_b32 v39, 0
    v_mov_b32 v40, 0
    v_mov_b32 v41, 0
    v_mov_b32 v42, 0
    v_mov_b32 v43, 0
    v_mov_b32 v44, 0
    v_mov_b32 v45, 0
    v_mov_b32 v46, 0
    v_mov_b32 v47, 0
    v_mov_b32 v48, 0
    v_mov_b32 v49, 0
    v_mov_b32 v50, 0
    v_mov_b32 v51, 0
    v_mov_b32 v52, 0
    v_mov_b32 v53, 0
    v_mov_b32 v54, 0
    v_mov_b32 v55, 0
    v_mov_b32 v56, 0
    v_mov_b32 v57, 0
    v_mov_b32 v58, 0
    v_mov_b32 v59, 0
    v_mov_b32 v60, 0
    v_mov_b32 v61, 0
    v_mov_b32 v62, 0
    v_mov_b32 v63, 0
    s_mov_b32 s30, 0
L_cv_loop_m:
    s_waitcnt lgkmcnt(0)
    v_mfma_f32_16x16x32_bf16 v[32:35], v[64:67], v[96:99], v[32:35]
    ds_read_b128 v[160:163], v24 offset:64
    v_mfma_f32_16x16x32_bf16 v[36:39], v[64:67], v[100:103], v[36:39]
    ds_read2_b32 v[128:129], v16 offset0:16 offset1:17
    v_mfma_f32_16x16x32_bf16 v[36:39], v[68:71], v[96:99], v[36:39]
    ds_read2_b32 v[130:131], v16 offset0:18 offset1:19
    v_mfma_f32_16x16x32_bf16 v[40:43], v[68:71], v[100:103], v[40:43]
    ds_read_b128 v[164:167], v24 offset:576
    v_mfma_f32_16x16x32_bf16 v[40:43], v[64:67], v[104:107], v[40:43]
    ds_read2_b32 v[132:133], v17 offset0:16 offset1:17
    v_mfma_f32_16x16x32_bf16 v[44:47], v[68:71], v[104:107], v[44:47]
    ds_read2_b32 v[134:135], v17 offset0:18 offset1:19
    v_mfma_f32_16x16x32_bf16 v[40:43], v[72:75], v[96:99], v[40:43]
    ds_read_b128 v[168:171], v24 offset:1088
    v_mfma_f32_16x16x32_bf16 v[44:47], v[72:75], v[100:103], v[44:47]
    ds_read2_b32 v[136:137], v18 offset0:16 offset1:17
    v_mfma_f32_16x16x32_bf16 v[48:51], v[72:75], v[104:107], v[48:51]
    ds_read2_b32 v[138:139], v18 offset0:18 offset1:19
    v_mfma_f32_16x16x32_bf16 v[44:47], v[64:67], v[108:111], v[44:47]
    ds_read_b128 v[172:175], v24 offset:1600
    v_mfma_f32_16x16x32_bf16 v[48:51], v[68:71], v[108:111], v[48:51]
    ds_read2_b32 v[140:141], v19 offset0:16 offset1:17
    v_mfma_f32_16x16x32_bf16 v[52:55], v[72:75], v[108:111], v[52:55]
    ds_read2_b32 v[142:143], v19 offset0:18 offset1:19
    v_mfma_f32_16x16x32_bf16 v[44:47], v[76:79], v[96:99], v[44:47]
    ds_read_b128 v[176:179], v24 offset:2112
    v_mfma_f32_16x16x32_bf16 v[48:51], v[76:79], v[100:103], v[48:51]
    ds_read2_b32 v[144:145], v20 offset0:16 offset1:17
    v_mfma_f32_16x16x32_bf16 v[52:55], v[76:79], v[104:107], v[52:55]
    ds_read2_b32 v[146:147], v20 offset0:18 offset1:19
    v_mfma_f32_16x16x32_bf16 v[56:59], v[76:79], v[108:111], v[56:59]
    ds_read_b128 v[180:183], v24 offset:2624
    v_mfma_f32_16x16x32_bf16 v[48:51], v[64:67], v[112:115], v[48:51]
    ds_read2_b32 v[148:149], v21 offset0:16 offset1:17
    v_mfma_f32_16x16x32_bf16 v[52:55], v[68:71], v[112:115], v[52:55]
    ds_read2_b32 v[150:151], v21 offset0:18 offset1:19
    v_mfma_f32_16x16x32_bf16 v[56:59], v[72:75], v[112:115], v[56:59]
    ds_read_b128 v[184:187], v24 offset:3136
    v_mfma_f32_16x16x32_bf16 v[60:63], v[76:79], v[112:115], v[60:63]
    ds_read2_b32 v[152:153], v22 offset0:16 offset1:17
    v_mfma_f32_16x16x32_bf16 v[48:51], v[80:83], v[96:99], v[48:51]
    ds_read2_b32 v[154:155], v22 offset0:18 offset1:19
    v_mfma_f32_16x16x32_bf16 v[52:55], v[80:83], v[100:103], v[52:55]
    ds_read_b128 v[188:191], v24 offset:3648
    v_mfma_f32_16x16x32_bf16 v[56:59], v[80:83], v[104:107], v[56:59]
    ds_read2_b32 v[156:157], v23 offset0:16 offset1:17
    v_mfma_f32_16x16x32_bf16 v[60:63], v[80:83], v[108:111], v[60:63]
    ds_read2_b32 v[158:159], v23 offset0:18 offset1:19
    v_mfma_f32_16x16x32_bf16 v[52:55], v[64:67], v[116:119], v[52:55]
    v_add_u32 v16, 128, v16
    v_mfma_f32_16x16x32_bf16 v[56:59], v[68:71], v[116:119], v[56:59]
    v_add_u32 v17, 128, v17
    v_mfma_f32_16x16x32_bf16 v[60:63], v[72:75], v[116:119], v[60:63]
    v_add_u32 v18, 128, v18
    v_mfma_f32_16x16x32_bf16 v[52:55], v[84:87], v[96:99], v[52:55]
    v_add_u32 v19, 128, v19
    v_mfma_f32_16x16x32_bf16 v[56:59], v[84:87], v[100:103], v[56:59]
    v_add_u32 v20, 128, v20
    v_mfma_f32_16x16x32_bf16 v[60:63], v[84:87], v[104:107], v[60:63]
    v_add_u32 v21, 128, v21
    v_mfma_f32_16x16x32_bf16 v[56:59], v[64:67], v[120:123], v[56:59]
    v_add_u32 v22, 128, v22
    v_mfma_f32_16x16x32_bf16 v[60:63], v[68:71], v[120:123], v[60:63]
    v_add_u32 v23, 128, v23
    v_mfma_f32_16x16x32_bf16 v[56:59], v[88:91], v[96:99], v[56:59]
    v_add_u32 v24, 128, v24
    v_mfma_f32_16x16x32_bf16 v[60:63], v[88:91], v[100:103], v[60:63]
    v_mfma_f32_16x16x32_bf16 v[60:63], v[64:67], v[124:127], v[60:63]
    v_mfma_f32_16x16x32_bf16 v[60:63], v[92:95], v[96:99], v[60:63]
    s_waitcnt lgkmcnt(0)
    v_mfma_f32_16x16x32_bf16 v[32:35], v[128:131], v[160:163], v[32:35]
    ds_read_b128 v[96:99], v24 offset:0
    v_mfma_f32_16x16x32_bf16 v[36:39], v[128:131], v[164:167], v[36:39]
    ds_read2_b32 v[64:65], v16 offset0:0 offset1:1
    v_mfma_f32_16x16x32_bf16 v[36:39], v[132:135], v[160:163], v[36:39]
    ds_read2_b32 v[66:67], v16 offset0:2 offset1:3
    v_mfma_f32_16x16x32_bf16 v[40:43], v[132:135], v[164:167], v[40:43]
    ds_read_b128 v[100:103], v24 offset:512
    v_mfma_f32_16x16x32_bf16 v[40:43], v[128:131], v[168:171], v[40:43]
    ds_read2_b32 v[68:69], v17 offset0:0 offset1:1
    v_mfma_f32_16x16x32_bf16 v[44:47], v[132:135], v[168:171], v[44:47]
    ds_read2_b32 v[70:71], v17 offset0:2 offset1:3
    v_mfma_f32_16x16x32_bf16 v[40:43], v[136:139], v[160:163], v[40:43]
    ds_read_b128 v[104:107], v24 offset:1024
    v_mfma_f32_16x16x32_bf16 v[44:47], v[136:139], v[164:167], v[44:47]
    ds_read2_b32 v[72:73], v18 offset0:0 offset1:1
    v_mfma_f32_16x16x32_bf16 v[48:51], v[136:139], v[168:171], v[48:51]
    ds_read2_b32 v[74:75], v18 offset0:2 offset1:3
    v_mfma_f32_16x16x32_bf16 v[44:47], v[128:131], v[172:175], v[44:47]
    ds_read_b128 v[108:111], v24 offset:1536
    v_mfma_f32_16x16x32_bf16 v[48:51], v[132:135], v[172:175], v[48:51]
    ds_read2_b32 v[76:77], v19 offset0:0 offset1:1
    v_mfma_f32_16x16x32_bf16 v[52:55], v[136:139], v[172:175], v[52:55]
    ds_read2_b32 v[78:79], v19 offset0:2 offset1:3
    v_mfma_f32_16x16x32_bf16 v[44:47], v[140:143], v[160:163], v[44:47]
    ds_read_b128 v[112:115], v24 offset:2048
    v_mfma_f32_16x16x32_bf16 v[48:51], v[140:143], v[164:167], v[48:51]
    ds_read2_b32 v[80:81], v20 offset0:0 offset1:1
    v_mfma_f32_16x16x32_bf16 v[52:55], v[140:143], v[168:171], v[52:55]
    ds_read2_b32 v[82:83], v20 offset0:2 offset1:3
    v_mfma_f32_16x16x32_bf16 v[56:59], v[140:143], v[172:175], v[56:59]
    ds_read_b128 v[116:119], v24 offset:2560
    v_mfma_f32_16x16x32_bf16 v[48:51], v[128:131], v[176:179], v[48:51]
    ds_read2_b32 v[84:85], v21 offset0:0 offset1:1
    v_mfma_f32_16x16x32_bf16 v[52:55], v[132:135], v[176:179], v[52:55]
    ds_read2_b32 v[86:87], v21 offset0:2 offset1:3
    v_mfma_f32_16x16x32_bf16 v[56:59], v[136:139], v[176:179], v[56:59]
    ds_read_b128 v[120:123], v24 offset:3072
    v_mfma_f32_16x16x32_bf16 v[60:63], v[140:143], v[176:179], v[60:63]
    ds_read2_b32 v[88:89], v22 offset0:0 offset1:1
    v_mfma_f32_16x16x32_bf16 v[48:51], v[144:147], v[160:163], v[48:51]
    ds_read2_b32 v[90:91], v22 offset0:2 offset1:3
    v_mfma_f32_16x16x32_bf16 v[52:55], v[144:147], v[164:167], v[52:55]
    ds_read_b128 v[124:127], v24 offset:3584
    v_mfma_f32_16x16x32_bf16 v[56:59], v[144:147], v[168:171], v[56:59]
    ds_read2_b32 v[92:93], v23 offset0:0 offset1:1
    v_mfma_f32_16x16x32_bf16 v[60:63], v[144:147], v[172:175], v[60:63]
    ds_read2_b32 v[94:95], v23 offset0:2 offset1:3
    v_mfma_f32_16x16x32_bf16 v[52:55], v[128:131], v[180:183], v[52:55]
    v_mfma_f32_16x16x32_bf16 v[56:59], v[132:135], v[180:183], v[56:59]
    v_mfma_f32_16x16x32_bf16 v[60:63], v[136:139], v[180:183], v[60:63]
    v_mfma_f32_16x16x32_bf16 v[52:55], v[148:151], v[160:163], v[52:55]
    v_mfma_f32_16x16x32_bf16 v[56:59], v[148:151], v[164:167], v[56:59]
    v_mfma_f32_16x16x32_bf16 v[60:63], v[148:151], v[168:171], v[60:63]
    v_mfma_f32_16x16x32_bf16 v[56:59], v[128:131], v[184:187], v[56:59]
    v_mfma_f32_16x16x32_bf16 v[60:63], v[132:135], v[184:187], v[60:63]
    v_mfma_f32_16x16x32_bf16 v[56:59], v[152:155], v[160:163], v[56:59]
    v_mfma_f32_16x16x32_bf16 v[60:63], v[152:155], v[164:167], v[60:63]
    v_mfma_f32_16x16x32_bf16 v[60:63], v[128:131], v[188:191], v[60:63]
    v_mfma_f32_16x16x32_bf16 v[60:63], v[156:159], v[160:163], v[60:63]
    s_add_u32 s30, s30, 1
    s_cmp_lt_u32 s30, 4
    s_cbranch_scc1 L_cv_loop_m
    s_waitcnt lgkmcnt(0)
    v_and_b32 v5, 15, v1
    v_lshrrev_b32 v6, 4, v1
    v_lshlrev_b32 v7, 5, v5
    v_lshl_add_u32 v7, v6, 3, v7
    s_mul_i32 s30, s25, 8352
    s_add_u32 s30, s30, 22328
    v_sub_u32 v7, s30, v7
    v_lshlrev_b32 v8, 4, v5
    v_lshl_add_u32 v8, v6, 2, v8
    s_mul_i32 s30, s25, 5184
    s_add_u32 s30, s30, 51072
    v_add_u32 v8, s30, v8
    ds_read_b64 v[64:65], v7 offset:3584
    ds_read_b64 v[66:67], v7 offset:3072
    ds_read_b64 v[68:69], v7 offset:2560
    ds_read_b64 v[70:71], v7 offset:2048
    ds_read_b64 v[72:73], v7 offset:1536
    ds_read_b64 v[74:75], v7 offset:1024
    ds_read_b64 v[76:77], v7 offset:512
    ds_read_b64 v[78:79], v7 offset:0
    s_waitcnt lgkmcnt(7)
    v_and_b32 v96, 0xffff0000, v65
    v_lshlrev_b32 v97, 16, v65
    v_and_b32 v98, 0xffff0000, v64
    v_lshlrev_b32 v99, 16, v64
    v_pk_mul_f32 v[96:97], v[96:97], v[30:31] op_sel_hi:[1,0]
    v_pk_mul_f32 v[98:99], v[98:99], v[30:31] op_sel_hi:[1,0]
    v_cvt_pk_bf16_f32 v100, v96, v97
    v_cvt_pk_bf16_f32 v101, v98, v99
    v_lshlrev_b32 v96, 16, v100
    v_and_b32 v97, 0xffff0000, v100
    v_lshlrev_b32 v98, 16, v101
    v_and_b32 v99, 0xffff0000, v101
    v_pk_add_f32 v[32:33], v[32:33], v[96:97]
    v_pk_add_f32 v[34:35], v[34:35], v[98:99]
    v_cvt_pk_bf16_f32 v32, v32, v34
    v_cvt_pk_bf16_f32 v33, v33, v35
    ds_write_b32 v8, v32 offset:0
    ds_write_b32 v8, v33 offset:2048
    s_waitcnt lgkmcnt(8)
    v_and_b32 v104, 0xffff0000, v67
    v_lshlrev_b32 v105, 16, v67
    v_and_b32 v106, 0xffff0000, v66
    v_lshlrev_b32 v107, 16, v66
    v_pk_mul_f32 v[104:105], v[104:105], v[30:31] op_sel_hi:[1,0]
    v_pk_mul_f32 v[106:107], v[106:107], v[30:31] op_sel_hi:[1,0]
    v_cvt_pk_bf16_f32 v108, v104, v105
    v_cvt_pk_bf16_f32 v109, v106, v107
    v_lshlrev_b32 v104, 16, v108
    v_and_b32 v105, 0xffff0000, v108
    v_lshlrev_b32 v106, 16, v109
    v_and_b32 v107, 0xffff0000, v109
    v_pk_add_f32 v[36:37], v[36:37], v[104:105]
    v_pk_add_f32 v[38:39], v[38:39], v[106:107]
    v_cvt_pk_bf16_f32 v36, v36, v38
    v_cvt_pk_bf16_f32 v37, v37, v39
    ds_write_b32 v8, v36 offset:256
    ds_write_b32 v8, v37 offset:2304
    s_waitcnt lgkmcnt(9)
    v_and_b32 v96, 0xffff0000, v69
    v_lshlrev_b32 v97, 16, v69
    v_and_b32 v98, 0xffff0000, v68
    v_lshlrev_b32 v99, 16, v68
    v_pk_mul_f32 v[96:97], v[96:97], v[30:31] op_sel_hi:[1,0]
    v_pk_mul_f32 v[98:99], v[98:99], v[30:31] op_sel_hi:[1,0]
    v_cvt_pk_bf16_f32 v100, v96, v97
    v_cvt_pk_bf16_f32 v101, v98, v99
    v_lshlrev_b32 v96, 16, v100
    v_and_b32 v97, 0xffff0000, v100
    v_lshlrev_b32 v98, 16, v101
    v_and_b32 v99, 0xffff0000, v101
    v_pk_add_f32 v[40:41], v[40:41], v[96:97]
    v_pk_add_f32 v[42:43], v[42:43], v[98:99]
    v_cvt_pk_bf16_f32 v40, v40, v42
    v_cvt_pk_bf16_f32 v41, v41, v43
    ds_write_b32 v8, v40 offset:512
    ds_write_b32 v8, v41 offset:2560
    s_waitcnt lgkmcnt(10)
    v_and_b32 v104, 0xffff0000, v71
    v_lshlrev_b32 v105, 16, v71
    v_and_b32 v106, 0xffff0000, v70
    v_lshlrev_b32 v107, 16, v70
    v_pk_mul_f32 v[104:105], v[104:105], v[30:31] op_sel_hi:[1,0]
    v_pk_mul_f32 v[106:107], v[106:107], v[30:31] op_sel_hi:[1,0]
    v_cvt_pk_bf16_f32 v108, v104, v105
    v_cvt_pk_bf16_f32 v109, v106, v107
    v_lshlrev_b32 v104, 16, v108
    v_and_b32 v105, 0xffff0000, v108
    v_lshlrev_b32 v106, 16, v109
    v_and_b32 v107, 0xffff0000, v109
    v_pk_add_f32 v[44:45], v[44:45], v[104:105]
    v_pk_add_f32 v[46:47], v[46:47], v[106:107]
    v_cvt_pk_bf16_f32 v44, v44, v46
    v_cvt_pk_bf16_f32 v45, v45, v47
    ds_write_b32 v8, v44 offset:768
    ds_write_b32 v8, v45 offset:2816
    s_waitcnt lgkmcnt(11)
    v_and_b32 v96, 0xffff0000, v73
    v_lshlrev_b32 v97, 16, v73
    v_and_b32 v98, 0xffff0000, v72
    v_lshlrev_b32 v99, 16, v72
    v_pk_mul_f32 v[96:97], v[96:97], v[30:31] op_sel_hi:[1,0]
    v_pk_mul_f32 v[98:99], v[98:99], v[30:31] op_sel_hi:[1,0]
    v_cvt_pk_bf16_f32 v100, v96, v97
    v_cvt_pk_bf16_f32 v101, v98, v99
    v_lshlrev_b32 v96, 16, v100
    v_and_b32 v97, 0xffff0000, v100
    v_lshlrev_b32 v98, 16, v101
    v_and_b32 v99, 0xffff0000, v101
    v_pk_add_f32 v[48:49], v[48:49], v[96:97]
    v_pk_add_f32 v[50:51], v[50:51], v[98:99]
    v_cvt_pk_bf16_f32 v48, v48, v50
    v_cvt_pk_bf16_f32 v49, v49, v51
    ds_write_b32 v8, v48 offset:1024
    ds_write_b32 v8, v49 offset:3072
    s_waitcnt lgkmcnt(12)
    v_and_b32 v104, 0xffff0000, v75
    v_lshlrev_b32 v105, 16, v75
    v_and_b32 v106, 0xffff0000, v74
    v_lshlrev_b32 v107, 16, v74
    v_pk_mul_f32 v[104:105], v[104:105], v[30:31] op_sel_hi:[1,0]
    v_pk_mul_f32 v[106:107], v[106:107], v[30:31] op_sel_hi:[1,0]
    v_cvt_pk_bf16_f32 v108, v104, v105
    v_cvt_pk_bf16_f32 v109, v106, v107
    v_lshlrev_b32 v104, 16, v108
    v_and_b32 v105, 0xffff0000, v108
    v_lshlrev_b32 v106, 16, v109
    v_and_b32 v107, 0xffff0000, v109
    v_pk_add_f32 v[52:53], v[52:53], v[104:105]
    v_pk_add_f32 v[54:55], v[54:55], v[106:107]
    v_cvt_pk_bf16_f32 v52, v52, v54
    v_cvt_pk_bf16_f32 v53, v53, v55
    ds_write_b32 v8, v52 offset:1280
    ds_write_b32 v8, v53 offset:3328
    s_waitcnt lgkmcnt(13)
    v_and_b32 v96, 0xffff0000, v77
    v_lshlrev_b32 v97, 16, v77
    v_and_b32 v98, 0xffff0000, v76
    v_lshlrev_b32 v99, 16, v76
    v_pk_mul_f32 v[96:97], v[96:97], v[30:31] op_sel_hi:[1,0]
    v_pk_mul_f32 v[98:99], v[98:99], v[30:31] op_sel_hi:[1,0]
    v_cvt_pk_bf16_f32 v100, v96, v97
    v_cvt_pk_bf16_f32 v101, v98, v99
    v_lshlrev_b32 v96, 16, v100
    v_and_b32 v97, 0xffff0000, v100
    v_lshlrev_b32 v98, 16, v101
    v_and_b32 v99, 0xffff0000, v101
    v_pk_add_f32 v[56:57], v[56:57], v[96:97]
    v_pk_add_f32 v[58:59], v[58:59], v[98:99]
    v_cvt_pk_bf16_f32 v56, v56, v58
    v_cvt_pk_bf16_f32 v57, v57, v59
    ds_write_b32 v8, v56 offset:1536
    ds_write_b32 v8, v57 offset:3584
    s_waitcnt lgkmcnt(14)
    v_and_b32 v104, 0xffff0000, v79
    v_lshlrev_b32 v105, 16, v79
    v_and_b32 v106, 0xffff0000, v78
    v_lshlrev_b32 v107, 16, v78
    v_pk_mul_f32 v[104:105], v[104:105], v[30:31] op_sel_hi:[1,0]
    v_pk_mul_f32 v[106:107], v[106:107], v[30:31] op_sel_hi:[1,0]
    v_cvt_pk_bf16_f32 v108, v104, v105
    v_cvt_pk_bf16_f32 v109, v106, v107
    v_lshlrev_b32 v104, 16, v108
    v_and_b32 v105, 0xffff0000, v108
    v_lshlrev_b32 v106, 16, v109
    v_and_b32 v107, 0xffff0000, v109
    v_pk_add_f32 v[60:61], v[60:61], v[104:105]
    v_pk_add_f32 v[62:63], v[62:63], v[106:107]
    v_cvt_pk_bf16_f32 v60, v60, v62
    v_cvt_pk_bf16_f32 v61, v61, v63
    ds_write_b32 v8, v60 offset:1792
    ds_write_b32 v8, v61 offset:3840
    s_branch L_cv_idle
L_cv_fetch:
L_cv_idle:
    s_waitcnt lgkmcnt(0)
    s_barrier
    v_lshrrev_b32 v5, 4, v1
    v_bfe_u32 v6, v1, 2, 2
    v_and_b32 v7, 3, v1
    v_mul_u32_u24 v8, 5184, v6
    v_lshl_add_u32 v8, v5, 5, v8
    v_lshl_add_u32 v8, v7, 3, v8
    s_lshl_b32 s30, s24, 7
    s_add_u32 s30, s30, 51072
    v_add_u32 v8, s30, v8
    v_lshlrev_b32 v10, 4, v1
    s_lshl_b32 s31, s24, 10
    s_add_u32 s30, s31, 71808
    v_add_u32 v9, s30, v10
    s_lshl_b32 s30, s36, 14
    s_add_u32 s30, s30, s31
    v_add_u32 v10, s30, v10
    ds_read_b64_tr_b16 v[32:33], v8 offset:0
    ds_read_b64_tr_b16 v[34:35], v8 offset:2048
    ds_read_b128 v[48:51], v9 offset:0
    ds_read_b64_tr_b16 v[36:37], v8 offset:1024
    ds_read_b64_tr_b16 v[38:39], v8 offset:3072
    ds_read_b128 v[52:55], v9 offset:8192
    s_waitcnt lgkmcnt(3)
    v_lshlrev_b32 v68, 16, v32
    v_and_b32 v69, 0xffff0000, v32
    v_lshlrev_b32 v70, 16, v48
    v_and_b32 v71, 0xffff0000, v48
    v_pk_add_f32 v[68:69], v[68:69], v[70:71]
    v_cvt_pk_bf16_f32 v64, v68, v69
    v_lshlrev_b32 v68, 16, v33
    v_and_b32 v69, 0xffff0000, v33
    v_lshlrev_b32 v70, 16, v49
    v_and_b32 v71, 0xffff0000, v49
    v_pk_add_f32 v[68:69], v[68:69], v[70:71]
    v_cvt_pk_bf16_f32 v65, v68, v69
    v_lshlrev_b32 v68, 16, v34
    v_and_b32 v69, 0xffff0000, v34
    v_lshlrev_b32 v70, 16, v50
    v_and_b32 v71, 0xffff0000, v50
    v_pk_add_f32 v[68:69], v[68:69], v[70:71]
    v_cvt_pk_bf16_f32 v66, v68, v69
    v_lshlrev_b32 v68, 16, v35
    v_and_b32 v69, 0xffff0000, v35
    v_lshlrev_b32 v70, 16, v51
    v_and_b32 v71, 0xffff0000, v51
    v_pk_add_f32 v[68:69], v[68:69], v[70:71]
    v_cvt_pk_bf16_f32 v67, v68, v69
    s_movk_i32 s30, 0
    buffer_store_dwordx4 v[64:67], v10, s[16:19], s30 offen sc1
    s_waitcnt lgkmcnt(0)
    v_lshlrev_b32 v80, 16, v36
    v_and_b32 v81, 0xffff0000, v36
    v_lshlrev_b32 v82, 16, v52
    v_and_b32 v83, 0xffff0000, v52
    v_pk_add_f32 v[80:81], v[80:81], v[82:83]
    v_cvt_pk_bf16_f32 v76, v80, v81
    v_lshlrev_b32 v80, 16, v37
    v_and_b32 v81, 0xffff0000, v37
    v_lshlrev_b32 v82, 16, v53
    v_and_b32 v83, 0xffff0000, v53
    v_pk_add_f32 v[80:81], v[80:81], v[82:83]
    v_cvt_pk_bf16_f32 v77, v80, v81
    v_lshlrev_b32 v80, 16, v38
    v_and_b32 v81, 0xffff0000, v38
    v_lshlrev_b32 v82, 16, v54
    v_and_b32 v83, 0xffff0000, v54
    v_pk_add_f32 v[80:81], v[80:81], v[82:83]
    v_cvt_pk_bf16_f32 v78, v80, v81
    v_lshlrev_b32 v80, 16, v39
    v_and_b32 v81, 0xffff0000, v39
    v_lshlrev_b32 v82, 16, v55
    v_and_b32 v83, 0xffff0000, v55
    v_pk_add_f32 v[80:81], v[80:81], v[82:83]
    v_cvt_pk_bf16_f32 v79, v80, v81
    s_movk_i32 s30, 8192
    buffer_store_dwordx4 v[76:79], v10, s[16:19], s30 offen sc1
L_fm_end:
    s_waitcnt vmcnt(0) lgkmcnt(0)
    s_barrier
    s_add_u32 s88, s6, 21102592
    s_addc_u32 s89, s7, 0
    s_mov_b32 s90, 65536
    s_mov_b32 s91, 131072
    s_cmp_lt_u32 s2, 64
    s_cbranch_scc1 L_mg_rp
    s_cmp_ge_u32 s2, 224
    s_cbranch_scc1 L_mg_rp
    s_cmp_eq_u32 s24, 0
    s_cbranch_scc0 L_s2a_done
    s_and_b32 s84, s2, 15
    s_lshl_b32 s84, s84, 7
    s_add_u32 s84, s84, 4096
    v_mov_b32 v6, s84
    v_mov_b32 v8, 1
    s_mov_b64 exec, 1
    buffer_atomic_add v8, v6, s[88:91], 0 offen sc0 sc1
    s_waitcnt vmcnt(0)
    v_readfirstlane_b32 s85, v8
    s_nop 0
    s_cmp_eq_u32 s85, 9
    s_cbranch_scc0 L_s2a_out
    v_mov_b32 v6, 6144
    v_mov_b32 v8, 1
    buffer_atomic_add v8, v6, s[88:91], 0 offen sc0 sc1
    s_waitcnt vmcnt(0)
    v_readfirstlane_b32 s85, v8
    s_nop 0
    s_cmp_eq_u32 s85, 15
    s_cbranch_scc0 L_s2a_out
    s_mov_b64 exec, 0xff
    v_lshlrev_b32 v6, 7, v1
    v_add_u32 v6, 6400, v6
    v_mov_b32 v8, 1
    buffer_store_dword v8, v6, s[88:91], 0 offen sc1
L_s2a_out:
    s_mov_b64 exec, -1
L_s2a_done:
    s_branch L_ffn_begin
L_mg_rp:
    s_load_dwordx2 s[76:77], s[0:1], 112
    s_waitcnt lgkmcnt(0)
    s_mov_b32 s78, 256
    s_mov_b32 s79, 131072
    s_cmp_eq_u32 s24, 0
    s_cbranch_scc0 L_s1w_done_mg
    v_mov_b32 v6, 0
    s_mov_b32 s30, 0
    s_mov_b64 exec, 1
L_s1w_poll_mg:
    buffer_load_dword v8, v6, s[76:79], 0 offen offset:128 sc1
    s_waitcnt vmcnt(0)
    v_readfirstlane_b32 s31, v8
    s_nop 0
    s_cmp_lg_u32 s31, 0
    s_cbranch_scc1 L_s1w_ok_mg
    s_add_u32 s30, s30, 1
    s_cmp_lt_u32 s30, 200000
    s_cbranch_scc1 L_s1w_poll_mg
L_s1w_ok_mg:
    s_mov_b64 exec, -1
L_s1w_done_mg:
    s_barrier
    s_cmp_eq_u32 s24, 0
    s_cbranch_scc0 L_rpa_done
    v_mov_b32 v6, 6272
    v_mov_b32 v8, 1
    s_mov_b64 exec, 1
    buffer_atomic_add v8, v6, s[88:91], 0 offen sc0 sc1
    s_waitcnt vmcnt(0)
    v_readfirstlane_b32 s85, v8
    s_nop 0
    s_cmp_eq_u32 s85, 95
    s_cbranch_scc0 L_rpa_out
    s_mov_b64 exec, 15
    v_lshlrev_b32 v6, 7, v1
    v_add_u32 v6, 7424, v6
    v_mov_b32 v8, 1
    buffer_store_dword v8, v6, s[88:91], 0 offen sc1
L_rpa_out:
    s_mov_b64 exec, -1
L_rpa_done:
L_ffn_begin:
    s_load_dwordx2 s[92:93], s[0:1], 104
    s_load_dwordx2 s[6:7], s[0:1], 120
    v_lshrrev_b32 v2, 6, v0
    v_and_b32 v1, 63, v0
    s_and_b32 s30, s2, 7
    s_lshr_b32 s31, s2, 3
    v_readfirstlane_b32 s24, v2
    s_lshr_b32 s25, s30, 2
    s_lshl_b32 s25, s25, 3
    s_and_b32 s26, s31, 7
    s_add_u32 s25, s25, s26
    s_and_b32 s26, s30, 3
    s_lshl_b32 s26, s26, 2
    s_lshr_b32 s31, s31, 3
    s_add_u32 s26, s26, s31
    s_mul_i32 s27, s26, 7
    s_mul_i32 s30, s26, 6
    s_add_u32 s30, s30, 12
    s_min_u32 s27, s27, s30
    s_waitcnt lgkmcnt(0)
    s_add_u32 s8, s6, 6291456
    s_addc_u32 s9, s7, 0
    s_mov_b32 s10, 2621440
    s_mov_b32 s11, 131072
    s_add_u32 s12, s6, 23068672
    s_addc_u32 s13, s7, 0
    s_mov_b32 s14, 4423680
    s_mov_b32 s15, 131072
    s_add_u32 s16, s6, 9437184
    s_addc_u32 s17, s7, 0
    s_mov_b32 s18, 7077888
    s_mov_b32 s19, 131072
    s_add_u32 s20, s6, 20971520
    s_addc_u32 s21, s7, 0
    s_mov_b32 s22, 55296
    s_mov_b32 s23, 131072
    s_add_u32 s36, s6, 21037056
    s_addc_u32 s37, s7, 0
    s_mov_b32 s38, 16384
    s_mov_b32 s39, 131072
    s_add_u32 s88, s6, 21102592
    s_addc_u32 s89, s7, 0
    s_mov_b32 s90, 65536
    s_mov_b32 s91, 131072
    s_cmp_ge_u32 s24, 4
    s_cbranch_scc1 L_ffn_loader_f
    v_lshrrev_b32 v10, 4, v1
    v_and_b32 v11, 15, v1
    v_mul_u32_u24 v2, 1152, v10
    v_lshl_add_u32 v2, v11, 3, v2
    s_and_b32 s30, s24, 1
    s_lshl_b32 s30, s30, 9
    v_add_u32 v2, s30, v2
    s_lshr_b32 s31, s24, 1
    s_lshl_b32 s32, s31, 8
    s_sub_u32 s29, 256, s32
    v_add_u32 v3, s29, v2
    v_add_u32 v2, s32, v2
    v_lshlrev_b32 v5, 4, v1
    s_lshl_b32 s32, s31, 13
    v_add_u32 v4, s32, v5
    v_mov_b32 v16, 0
    v_mov_b32 v17, 0
    v_mov_b32 v18, 0
    v_mov_b32 v19, 0
    v_mov_b32 v20, 0
    v_mov_b32 v21, 0
    v_mov_b32 v22, 0
    v_mov_b32 v23, 0
    v_mov_b32 v24, 0
    v_mov_b32 v25, 0
    v_mov_b32 v26, 0
    v_mov_b32 v27, 0
    v_mov_b32 v28, 0
    v_mov_b32 v29, 0
    v_mov_b32 v30, 0
    v_mov_b32 v31, 0
    v_mov_b32 v32, 0
    v_mov_b32 v33, 0
    v_mov_b32 v34, 0
    v_mov_b32 v35, 0
    v_mov_b32 v36, 0
    v_mov_b32 v37, 0
    v_mov_b32 v38, 0
    v_mov_b32 v39, 0
    v_mov_b32 v40, 0
    v_mov_b32 v41, 0
    v_mov_b32 v42, 0
    v_mov_b32 v43, 0
    v_mov_b32 v44, 0
    v_mov_b32 v45, 0
    v_mov_b32 v46, 0
    v_mov_b32 v47, 0
    v_mov_b32 v48, 0
    v_mov_b32 v49, 0
    v_mov_b32 v50, 0
    v_mov_b32 v51, 0
    v_mov_b32 v52, 0
    v_mov_b32 v53, 0
    v_mov_b32 v54, 0
    v_mov_b32 v55, 0
    v_mov_b32 v56, 0
    v_mov_b32 v57, 0
    v_mov_b32 v58, 0
    v_mov_b32 v59, 0
    v_mov_b32 v60, 0
    v_mov_b32 v61, 0
    v_mov_b32 v62, 0
    v_mov_b32 v63, 0
    v_mov_b32 v64, 0
    v_mov_b32 v65, 0
    v_mov_b32 v66, 0
    v_mov_b32 v67, 0
    v_mov_b32 v68, 0
    v_mov_b32 v69, 0
    v_mov_b32 v70, 0
    v_mov_b32 v71, 0
    v_mov_b32 v72, 0
    v_mov_b32 v73, 0
    v_mov_b32 v74, 0
    v_mov_b32 v75, 0
    v_mov_b32 v76, 0
    v_mov_b32 v77, 0
    v_mov_b32 v78, 0
    v_mov_b32 v79, 0
    v_mov_b32 v80, 0
    v_mov_b32 v81, 0
    v_mov_b32 v82, 0
    v_mov_b32 v83, 0
    v_mov_b32 v84, 0
    v_mov_b32 v85, 0
    v_mov_b32 v86, 0
    v_mov_b32 v87, 0
    v_mov_b32 v88, 0
    v_mov_b32 v89, 0
    v_mov_b32 v90, 0
    v_mov_b32 v91, 0
    v_mov_b32 v92, 0
    v_mov_b32 v93, 0
    v_mov_b32 v94, 0
    v_mov_b32 v95, 0
    v_mov_b32 v96, 0
    v_mov_b32 v97, 0
    v_mov_b32 v98, 0
    v_mov_b32 v99, 0
    v_mov_b32 v100, 0
    v_mov_b32 v101, 0
    v_mov_b32 v102, 0
    v_mov_b32 v103, 0
    v_mov_b32 v104, 0
    v_mov_b32 v105, 0
    v_mov_b32 v106, 0
    v_mov_b32 v107, 0
    v_mov_b32 v108, 0
    v_mov_b32 v109, 0
    v_mov_b32 v110, 0
    v_mov_b32 v111, 0
    v_mov_b32 v112, 0
    v_mov_b32 v113, 0
    v_mov_b32 v114, 0
    v_mov_b32 v115, 0
    v_mov_b32 v116, 0
    v_mov_b32 v117, 0
    v_mov_b32 v118, 0
    v_mov_b32 v119, 0
    v_mov_b32 v120, 0
    v_mov_b32 v121, 0
    v_mov_b32 v122, 0
    v_mov_b32 v123, 0
    v_mov_b32 v124, 0
    v_mov_b32 v125, 0
    v_mov_b32 v126, 0
    v_mov_b32 v127, 0
    s_mov_b32 s28, 0
    v_add_u32 v6, s28, v2
    v_add_u32 v7, s28, v3
    v_add_u32 v8, s28, v4
    v_add_u32 v9, s28, v5
    s_cmp_eq_u32 s24, 0
    s_cbranch_scc0 L_s2w_done
    s_and_b32 s84, s2, 7
    s_lshl_b32 s84, s84, 7
    s_add_u32 s84, s84, 6400
    v_mov_b32 v246, s84
    s_mov_b32 s85, 0
    s_mov_b64 exec, 1
L_s2w_poll:
    buffer_load_dword v247, v246, s[88:91], 0 offen sc1
    s_waitcnt vmcnt(0)
    v_readfirstlane_b32 s94, v247
    s_nop 0
    s_cmp_lg_u32 s94, 0
    s_cbranch_scc1 L_s2w_ok
    s_add_u32 s85, s85, 1
    s_cmp_lt_u32 s85, 200000
    s_cbranch_scc1 L_s2w_poll
L_s2w_ok:
    s_mov_b64 exec, -1
L_s2w_done:
    s_barrier
    s_barrier
    ds_read_b64 v[160:161], v6 offset:14336
    ds_read_b64 v[162:163], v6 offset:18944
    ds_read_b64 v[164:165], v6 offset:14464
    ds_read_b64 v[166:167], v6 offset:19072
    ds_read_b64 v[168:169], v7 offset:14336
    ds_read_b64 v[170:171], v7 offset:18944
    ds_read_b64 v[172:173], v7 offset:14464
    ds_read_b64 v[174:175], v7 offset:19072
    ds_read_b128 v[128:131], v8 offset:0
    ds_read_b128 v[132:135], v8 offset:1024
    ds_read_b128 v[136:139], v8 offset:2048
    ds_read_b128 v[140:143], v8 offset:3072
    ds_read_b128 v[144:147], v8 offset:4096
    ds_read_b128 v[148:151], v8 offset:5120
    ds_read_b128 v[152:155], v9 offset:6144
    ds_read_b128 v[156:159], v9 offset:7168
    s_mov_b32 s29, 0
L_g1_c_f:
    s_waitcnt lgkmcnt(7)
    v_mfma_f32_16x16x32_bf16 v[16:19], v[128:131], v[160:163], v[16:19]
    ds_read_b64 v[208:209], v6 offset:37888
    v_mfma_f32_16x16x32_bf16 v[20:23], v[128:131], v[164:167], v[20:23]
    ds_read_b64 v[210:211], v6 offset:42496
    v_mfma_f32_16x16x32_bf16 v[24:27], v[128:131], v[168:171], v[24:27]
    ds_read_b64 v[212:213], v6 offset:38016
    v_mfma_f32_16x16x32_bf16 v[28:31], v[128:131], v[172:175], v[28:31]
    ds_read_b64 v[214:215], v6 offset:42624
    s_waitcnt lgkmcnt(10)
    v_mfma_f32_16x16x32_bf16 v[32:35], v[132:135], v[160:163], v[32:35]
    ds_read_b64 v[216:217], v7 offset:37888
    v_mfma_f32_16x16x32_bf16 v[36:39], v[132:135], v[164:167], v[36:39]
    ds_read_b64 v[218:219], v7 offset:42496
    v_mfma_f32_16x16x32_bf16 v[40:43], v[132:135], v[168:171], v[40:43]
    ds_read_b64 v[220:221], v7 offset:38016
    v_mfma_f32_16x16x32_bf16 v[44:47], v[132:135], v[172:175], v[44:47]
    ds_read_b64 v[222:223], v7 offset:42624
    s_waitcnt lgkmcnt(13)
    v_mfma_f32_16x16x32_bf16 v[48:51], v[136:139], v[160:163], v[48:51]
    ds_read_b128 v[176:179], v8 offset:23552
    v_mfma_f32_16x16x32_bf16 v[52:55], v[136:139], v[164:167], v[52:55]
    ds_read_b128 v[180:183], v8 offset:24576
    v_mfma_f32_16x16x32_bf16 v[56:59], v[136:139], v[168:171], v[56:59]
    ds_read_b128 v[184:187], v8 offset:25600
    v_mfma_f32_16x16x32_bf16 v[60:63], v[136:139], v[172:175], v[60:63]
    ds_read_b128 v[188:191], v8 offset:26624
    s_waitcnt lgkmcnt(15)
    v_mfma_f32_16x16x32_bf16 v[64:67], v[140:143], v[160:163], v[64:67]
    ds_read_b128 v[192:195], v8 offset:27648
    v_mfma_f32_16x16x32_bf16 v[68:71], v[140:143], v[164:167], v[68:71]
    ds_read_b128 v[196:199], v8 offset:28672
    v_mfma_f32_16x16x32_bf16 v[72:75], v[140:143], v[168:171], v[72:75]
    ds_read_b128 v[200:203], v9 offset:29696
    v_mfma_f32_16x16x32_bf16 v[76:79], v[140:143], v[172:175], v[76:79]
    ds_read_b128 v[204:207], v9 offset:30720
    v_mfma_f32_16x16x32_bf16 v[80:83], v[144:147], v[160:163], v[80:83]
    v_mfma_f32_16x16x32_bf16 v[84:87], v[144:147], v[164:167], v[84:87]
    v_mfma_f32_16x16x32_bf16 v[88:91], v[144:147], v[168:171], v[88:91]
    v_mfma_f32_16x16x32_bf16 v[92:95], v[144:147], v[172:175], v[92:95]
    s_waitcnt lgkmcnt(15)
    v_mfma_f32_16x16x32_bf16 v[96:99], v[148:151], v[160:163], v[96:99]
    v_mfma_f32_16x16x32_bf16 v[100:103], v[148:151], v[164:167], v[100:103]
    v_mfma_f32_16x16x32_bf16 v[104:107], v[148:151], v[168:171], v[104:107]
    v_mfma_f32_16x16x32_bf16 v[108:111], v[148:151], v[172:175], v[108:111]
    v_mfma_f32_16x16x32_bf16 v[112:115], v[152:155], v[160:163], v[112:115]
    v_mfma_f32_16x16x32_bf16 v[116:119], v[152:155], v[164:167], v[116:119]
    v_mfma_f32_16x16x32_bf16 v[120:123], v[156:159], v[160:163], v[120:123]
    v_mfma_f32_16x16x32_bf16 v[124:127], v[156:159], v[164:167], v[124:127]
    s_waitcnt lgkmcnt(0)
    s_add_u32 s28, s28, 47104
    s_sub_u32 s30, s28, 141312
    s_cmp_ge_u32 s28, 141312
    s_cselect_b32 s28, s30, s28
    s_barrier
    v_add_u32 v6, s28, v2
    v_add_u32 v7, s28, v3
    v_add_u32 v8, s28, v4
    v_add_u32 v9, s28, v5
    v_mfma_f32_16x16x32_bf16 v[16:19], v[176:179], v[208:211], v[16:19]
    ds_read_b64 v[160:161], v6 offset:14336
    v_mfma_f32_16x16x32_bf16 v[20:23], v[176:179], v[212:215], v[20:23]
    ds_read_b64 v[162:163], v6 offset:18944
    v_mfma_f32_16x16x32_bf16 v[24:27], v[176:179], v[216:219], v[24:27]
    ds_read_b64 v[164:165], v6 offset:14464
    v_mfma_f32_16x16x32_bf16 v[28:31], v[176:179], v[220:223], v[28:31]
    ds_read_b64 v[166:167], v6 offset:19072
    v_mfma_f32_16x16x32_bf16 v[32:35], v[180:183], v[208:211], v[32:35]
    ds_read_b64 v[168:169], v7 offset:14336
    v_mfma_f32_16x16x32_bf16 v[36:39], v[180:183], v[212:215], v[36:39]
    ds_read_b64 v[170:171], v7 offset:18944
    v_mfma_f32_16x16x32_bf16 v[40:43], v[180:183], v[216:219], v[40:43]
    ds_read_b64 v[172:173], v7 offset:14464
    v_mfma_f32_16x16x32_bf16 v[44:47], v[180:183], v[220:223], v[44:47]
    ds_read_b64 v[174:175], v7 offset:19072
    v_mfma_f32_16x16x32_bf16 v[48:51], v[184:187], v[208:211], v[48:51]
    ds_read_b128 v[128:131], v8 offset:0
    v_mfma_f32_16x16x32_bf16 v[52:55], v[184:187], v[212:215], v[52:55]
    ds_read_b128 v[132:135], v8 offset:1024
    v_mfma_f32_16x16x32_bf16 v[56:59], v[184:187], v[216:219], v[56:59]
    ds_read_b128 v[136:139], v8 offset:2048
    v_mfma_f32_16x16x32_bf16 v[60:63], v[184:187], v[220:223], v[60:63]
    ds_read_b128 v[140:143], v8 offset:3072
    v_mfma_f32_16x16x32_bf16 v[64:67], v[188:191], v[208:211], v[64:67]
    ds_read_b128 v[144:147], v8 offset:4096
    v_mfma_f32_16x16x32_bf16 v[68:71], v[188:191], v[212:215], v[68:71]
    ds_read_b128 v[148:151], v8 offset:5120
    v_mfma_f32_16x16x32_bf16 v[72:75], v[188:191], v[216:219], v[72:75]
    ds_read_b128 v[152:155], v9 offset:6144
    v_mfma_f32_16x16x32_bf16 v[76:79], v[188:191], v[220:223], v[76:79]
    ds_read_b128 v[156:159], v9 offset:7168
    v_mfma_f32_16x16x32_bf16 v[80:83], v[192:195], v[208:211], v[80:83]
    v_mfma_f32_16x16x32_bf16 v[84:87], v[192:195], v[212:215], v[84:87]
    v_mfma_f32_16x16x32_bf16 v[88:91], v[192:195], v[216:219], v[88:91]
    v_mfma_f32_16x16x32_bf16 v[92:95], v[192:195], v[220:223], v[92:95]
    v_mfma_f32_16x16x32_bf16 v[96:99], v[196:199], v[208:211], v[96:99]
    v_mfma_f32_16x16x32_bf16 v[100:103], v[196:199], v[212:215], v[100:103]
    v_mfma_f32_16x16x32_bf16 v[104:107], v[196:199], v[216:219], v[104:107]
    v_mfma_f32_16x16x32_bf16 v[108:111], v[196:199], v[220:223], v[108:111]
    v_mfma_f32_16x16x32_bf16 v[112:115], v[200:203], v[208:211], v[112:115]
    v_mfma_f32_16x16x32_bf16 v[116:119], v[200:203], v[212:215], v[116:119]
    v_mfma_f32_16x16x32_bf16 v[120:123], v[204:207], v[208:211], v[120:123]
    v_mfma_f32_16x16x32_bf16 v[124:127], v[204:207], v[212:215], v[124:127]
    s_add_u32 s29, s29, 1
    s_cmp_lt_u32 s29, 9
    s_cbranch_scc1 L_g1_c_f
    s_waitcnt lgkmcnt(7)
    v_mfma_f32_16x16x32_bf16 v[16:19], v[128:131], v[160:163], v[16:19]
    ds_read_b64 v[208:209], v6 offset:37888
    v_mfma_f32_16x16x32_bf16 v[20:23], v[128:131], v[164:167], v[20:23]
    ds_read_b64 v[210:211], v6 offset:42496
    v_mfma_f32_16x16x32_bf16 v[24:27], v[128:131], v[168:171], v[24:27]
    ds_read_b64 v[212:213], v6 offset:38016
    v_mfma_f32_16x16x32_bf16 v[28:31], v[128:131], v[172:175], v[28:31]
    ds_read_b64 v[214:215], v6 offset:42624
    s_waitcnt lgkmcnt(10)
    v_mfma_f32_16x16x32_bf16 v[32:35], v[132:135], v[160:163], v[32:35]
    ds_read_b64 v[216:217], v7 offset:37888
    v_mfma_f32_16x16x32_bf16 v[36:39], v[132:135], v[164:167], v[36:39]
    ds_read_b64 v[218:219], v7 offset:42496
    v_mfma_f32_16x16x32_bf16 v[40:43], v[132:135], v[168:171], v[40:43]
    ds_read_b64 v[220:221], v7 offset:38016
    v_mfma_f32_16x16x32_bf16 v[44:47], v[132:135], v[172:175], v[44:47]
    ds_read_b64 v[222:223], v7 offset:42624
    s_waitcnt lgkmcnt(13)
    v_mfma_f32_16x16x32_bf16 v[48:51], v[136:139], v[160:163], v[48:51]
    ds_read_b128 v[176:179], v8 offset:23552
    v_mfma_f32_16x16x32_bf16 v[52:55], v[136:139], v[164:167], v[52:55]
    ds_read_b128 v[180:183], v8 offset:24576
    v_mfma_f32_16x16x32_bf16 v[56:59], v[136:139], v[168:171], v[56:59]
    ds_read_b128 v[184:187], v8 offset:25600
    v_mfma_f32_16x16x32_bf16 v[60:63], v[136:139], v[172:175], v[60:63]
    ds_read_b128 v[188:191], v8 offset:26624
    s_waitcnt lgkmcnt(15)
    v_mfma_f32_16x16x32_bf16 v[64:67], v[140:143], v[160:163], v[64:67]
    ds_read_b128 v[192:195], v8 offset:27648
    v_mfma_f32_16x16x32_bf16 v[68:71], v[140:143], v[164:167], v[68:71]
    ds_read_b128 v[196:199], v8 offset:28672
    v_mfma_f32_16x16x32_bf16 v[72:75], v[140:143], v[168:171], v[72:75]
    ds_read_b128 v[200:203], v9 offset:29696
    v_mfma_f32_16x16x32_bf16 v[76:79], v[140:143], v[172:175], v[76:79]
    ds_read_b128 v[204:207], v9 offset:30720
    v_mfma_f32_16x16x32_bf16 v[80:83], v[144:147], v[160:163], v[80:83]
    v_mfma_f32_16x16x32_bf16 v[84:87], v[144:147], v[164:167], v[84:87]
    v_mfma_f32_16x16x32_bf16 v[88:91], v[144:147], v[168:171], v[88:91]
    v_mfma_f32_16x16x32_bf16 v[92:95], v[144:147], v[172:175], v[92:95]
    s_waitcnt lgkmcnt(15)
    v_mfma_f32_16x16x32_bf16 v[96:99], v[148:151], v[160:163], v[96:99]
    v_mfma_f32_16x16x32_bf16 v[100:103], v[148:151], v[164:167], v[100:103]
    v_mfma_f32_16x16x32_bf16 v[104:107], v[148:151], v[168:171], v[104:107]
    v_mfma_f32_16x16x32_bf16 v[108:111], v[148:151], v[172:175], v[108:111]
    v_mfma_f32_16x16x32_bf16 v[112:115], v[152:155], v[160:163], v[112:115]
    v_mfma_f32_16x16x32_bf16 v[116:119], v[152:155], v[164:167], v[116:119]
    v_mfma_f32_16x16x32_bf16 v[120:123], v[156:159], v[160:163], v[120:123]
    v_mfma_f32_16x16x32_bf16 v[124:127], v[156:159], v[164:167], v[124:127]
    s_waitcnt lgkmcnt(0)
    s_barrier
    v_mfma_f32_16x16x32_bf16 v[16:19], v[176:179], v[208:211], v[16:19]
    v_mfma_f32_16x16x32_bf16 v[20:23], v[176:179], v[212:215], v[20:23]
    v_mfma_f32_16x16x32_bf16 v[24:27], v[176:179], v[216:219], v[24:27]
    v_mfma_f32_16x16x32_bf16 v[28:31], v[176:179], v[220:223], v[28:31]
    v_mfma_f32_16x16x32_bf16 v[32:35], v[180:183], v[208:211], v[32:35]
    v_mfma_f32_16x16x32_bf16 v[36:39], v[180:183], v[212:215], v[36:39]
    v_mfma_f32_16x16x32_bf16 v[40:43], v[180:183], v[216:219], v[40:43]
    v_mfma_f32_16x16x32_bf16 v[44:47], v[180:183], v[220:223], v[44:47]
    v_mfma_f32_16x16x32_bf16 v[48:51], v[184:187], v[208:211], v[48:51]
    v_mfma_f32_16x16x32_bf16 v[52:55], v[184:187], v[212:215], v[52:55]
    v_mfma_f32_16x16x32_bf16 v[56:59], v[184:187], v[216:219], v[56:59]
    v_mfma_f32_16x16x32_bf16 v[60:63], v[184:187], v[220:223], v[60:63]
    v_mfma_f32_16x16x32_bf16 v[64:67], v[188:191], v[208:211], v[64:67]
    v_mfma_f32_16x16x32_bf16 v[68:71], v[188:191], v[212:215], v[68:71]
    v_mfma_f32_16x16x32_bf16 v[72:75], v[188:191], v[216:219], v[72:75]
    v_mfma_f32_16x16x32_bf16 v[76:79], v[188:191], v[220:223], v[76:79]
    v_mfma_f32_16x16x32_bf16 v[80:83], v[192:195], v[208:211], v[80:83]
    v_mfma_f32_16x16x32_bf16 v[84:87], v[192:195], v[212:215], v[84:87]
    v_mfma_f32_16x16x32_bf16 v[88:91], v[192:195], v[216:219], v[88:91]
    v_mfma_f32_16x16x32_bf16 v[92:95], v[192:195], v[220:223], v[92:95]
    v_mfma_f32_16x16x32_bf16 v[96:99], v[196:199], v[208:211], v[96:99]
    v_mfma_f32_16x16x32_bf16 v[100:103], v[196:199], v[212:215], v[100:103]
    v_mfma_f32_16x16x32_bf16 v[104:107], v[196:199], v[216:219], v[104:107]
    v_mfma_f32_16x16x32_bf16 v[108:111], v[196:199], v[220:223], v[108:111]
    v_mfma_f32_16x16x32_bf16 v[112:115], v[200:203], v[208:211], v[112:115]
    v_mfma_f32_16x16x32_bf16 v[116:119], v[200:203], v[212:215], v[116:119]
    v_mfma_f32_16x16x32_bf16 v[120:123], v[204:207], v[208:211], v[120:123]
    v_mfma_f32_16x16x32_bf16 v[124:127], v[204:207], v[212:215], v[124:127]
    v_and_b32 v11, 15, v1
    v_lshlrev_b32 v11, 3, v11
    v_add_u32 v11, 144384, v11
    s_and_b32 s30, s24, 1
    s_lshl_b32 s30, s30, 9
    v_add_u32 v11, s30, v11
    s_lshr_b32 s31, s24, 1
    s_lshl_b32 s32, s31, 8
    s_sub_u32 s29, 256, s32
    v_add_u32 v7, s29, v11
    v_add_u32 v6, s32, v11
    v_lshrrev_b32 v10, 4, v1
    v_lshlrev_b32 v10, 4, v10
    v_add_u32 v10, 143360, v10
    s_lshl_b32 s32, s31, 8
    v_add_u32 v8, s32, v10
    ds_read_b64 v[128:129], v6 offset:0
    ds_read_b64 v[130:131], v6 offset:128
    ds_read_b64 v[132:133], v7 offset:0
    ds_read_b64 v[134:135], v7 offset:128
    ds_read_b128 v[144:147], v8 offset:0
    ds_read_b128 v[148:151], v8 offset:448
    ds_read_b128 v[152:155], v8 offset:64
    ds_read_b128 v[156:159], v8 offset:512
    ds_read_b128 v[160:163], v8 offset:128
    ds_read_b128 v[164:167], v8 offset:576
    ds_read_b128 v[168:171], v10 offset:192
    ds_read_b128 v[172:175], v10 offset:640
    v_lshlrev_b32 v12, 4, v1
    s_and_b32 s30, s24, 1
    s_lshl_b32 s30, s30, 1
    s_lshl_b32 s32, s25, 2
    s_add_u32 s32, s32, s30
    s_add_u32 s33, s32, s31
    s_sub_u32 s34, 1, s31
    s_add_u32 s34, s34, s32
    s_mul_i32 s33, s33, 108
    s_mul_i32 s34, s34, 108
    s_add_u32 s33, s33, s27
    s_add_u32 s34, s34, s27
    s_lshl_b32 s33, s33, 10
    s_lshl_b32 s34, s34, 10
    s_lshl_b32 s28, s31, 12
    s_cmp_ge_u32 s26, 12
    s_cselect_b32 s35, s31, 0
    s_lshl_b32 s35, s35, 30
    v_mov_b32 v176, 1.0
    v_mov_b32 v177, 1.0
    s_waitcnt lgkmcnt(0)
    v_mul_f32 v136, v129, v129
    v_mul_f32 v129, 0xbfb8aa3b, v129
    v_sub_f32 v128, 0, v128
    v_mul_f32 v138, v131, v131
    v_mul_f32 v131, 0xbfb8aa3b, v131
    v_sub_f32 v130, 0, v130
    v_mul_f32 v140, v133, v133
    v_mul_f32 v133, 0xbfb8aa3b, v133
    v_sub_f32 v132, 0, v132
    v_mul_f32 v142, v135, v135
    v_mul_f32 v135, 0xbfb8aa3b, v135
    v_sub_f32 v134, 0, v134
    v_rcp_f32 v136, v136
    v_rcp_f32 v138, v138
    v_rcp_f32 v140, v140
    v_rcp_f32 v142, v142
    s_add_u32 s30, s28, 0
    v_pk_fma_f32 v[178:179], v[144:145], v[128:129], v[16:17] op_sel:[0,0,0] op_sel_hi:[1,0,1]
    v_pk_fma_f32 v[180:181], v[146:147], v[128:129], v[18:19] op_sel:[0,0,0] op_sel_hi:[1,0,1]
    v_pk_fma_f32 v[182:183], v[144:145], v[130:131], v[20:21] op_sel:[0,0,0] op_sel_hi:[1,0,1]
    v_pk_fma_f32 v[184:185], v[146:147], v[130:131], v[22:23] op_sel:[0,0,0] op_sel_hi:[1,0,1]
    v_pk_fma_f32 v[186:187], v[148:149], v[128:129], v[32:33] op_sel:[0,0,0] op_sel_hi:[1,0,1]
    v_pk_fma_f32 v[188:189], v[150:151], v[128:129], v[34:35] op_sel:[0,0,0] op_sel_hi:[1,0,1]
    v_pk_fma_f32 v[190:191], v[148:149], v[130:131], v[36:37] op_sel:[0,0,0] op_sel_hi:[1,0,1]
    v_pk_fma_f32 v[192:193], v[150:151], v[130:131], v[38:39] op_sel:[0,0,0] op_sel_hi:[1,0,1]
    v_pk_mul_f32 v[194:195], v[178:179], v[128:129] op_sel:[0,1] op_sel_hi:[1,1]
    v_pk_mul_f32 v[196:197], v[180:181], v[128:129] op_sel:[0,1] op_sel_hi:[1,1]
    v_pk_mul_f32 v[198:199], v[182:183], v[130:131] op_sel:[0,1] op_sel_hi:[1,1]
    v_pk_mul_f32 v[200:201], v[184:185], v[130:131] op_sel:[0,1] op_sel_hi:[1,1]
    v_exp_f32 v194, v194
    v_exp_f32 v195, v195
    v_exp_f32 v196, v196
    v_exp_f32 v197, v197
    v_exp_f32 v198, v198
    v_exp_f32 v199, v199
    v_exp_f32 v200, v200
    v_exp_f32 v201, v201
    v_pk_mul_f32 v[178:179], v[178:179], v[186:187]
    v_pk_mul_f32 v[180:181], v[180:181], v[188:189]
    v_pk_mul_f32 v[182:183], v[182:183], v[190:191]
    v_pk_mul_f32 v[184:185], v[184:185], v[192:193]
    v_pk_fma_f32 v[194:195], v[194:195], v[136:137], v[136:137] op_sel:[0,0,0] op_sel_hi:[1,0,0]
    v_pk_fma_f32 v[196:197], v[196:197], v[136:137], v[136:137] op_sel:[0,0,0] op_sel_hi:[1,0,0]
    v_pk_fma_f32 v[198:199], v[198:199], v[138:139], v[138:139] op_sel:[0,0,0] op_sel_hi:[1,0,0]
    v_pk_fma_f32 v[200:201], v[200:201], v[138:139], v[138:139] op_sel:[0,0,0] op_sel_hi:[1,0,0]
    v_rcp_f32 v194, v194
    v_rcp_f32 v195, v195
    v_rcp_f32 v196, v196
    v_rcp_f32 v197, v197
    v_rcp_f32 v198, v198
    v_rcp_f32 v199, v199
    v_rcp_f32 v200, v200
    v_rcp_f32 v201, v201
    v_pk_mul_f32 v[178:179], v[178:179], v[194:195]
    v_pk_mul_f32 v[180:181], v[180:181], v[196:197]
    v_pk_mul_f32 v[182:183], v[182:183], v[198:199]
    v_pk_mul_f32 v[184:185], v[184:185], v[200:201]
    v_cvt_pk_bf16_f32 v204, v178, v179
    v_cvt_pk_bf16_f32 v205, v180, v181
    v_cvt_pk_bf16_f32 v206, v182, v183
    v_cvt_pk_bf16_f32 v207, v184, v185
    s_add_u32 s32, s33, s30
    buffer_store_dwordx4 v[204:207], v12, s[16:19], s32 offen sc1
    v_pk_fma_f32 v[178:179], v[144:145], v[132:133], v[24:25] op_sel:[0,0,0] op_sel_hi:[1,0,1]
    v_pk_fma_f32 v[180:181], v[146:147], v[132:133], v[26:27] op_sel:[0,0,0] op_sel_hi:[1,0,1]
    v_pk_fma_f32 v[182:183], v[144:145], v[134:135], v[28:29] op_sel:[0,0,0] op_sel_hi:[1,0,1]
    v_pk_fma_f32 v[184:185], v[146:147], v[134:135], v[30:31] op_sel:[0,0,0] op_sel_hi:[1,0,1]
    v_pk_fma_f32 v[186:187], v[148:149], v[132:133], v[40:41] op_sel:[0,0,0] op_sel_hi:[1,0,1]
    v_pk_fma_f32 v[188:189], v[150:151], v[132:133], v[42:43] op_sel:[0,0,0] op_sel_hi:[1,0,1]
    v_pk_fma_f32 v[190:191], v[148:149], v[134:135], v[44:45] op_sel:[0,0,0] op_sel_hi:[1,0,1]
    v_pk_fma_f32 v[192:193], v[150:151], v[134:135], v[46:47] op_sel:[0,0,0] op_sel_hi:[1,0,1]
    v_pk_mul_f32 v[194:195], v[178:179], v[132:133] op_sel:[0,1] op_sel_hi:[1,1]
    v_pk_mul_f32 v[196:197], v[180:181], v[132:133] op_sel:[0,1] op_sel_hi:[1,1]
    v_pk_mul_f32 v[198:199], v[182:183], v[134:135] op_sel:[0,1] op_sel_hi:[1,1]
    v_pk_mul_f32 v[200:201], v[184:185], v[134:135] op_sel:[0,1] op_sel_hi:[1,1]
    v_exp_f32 v194, v194
    v_exp_f32 v195, v195
    v_exp_f32 v196, v196
    v_exp_f32 v197, v197
    v_exp_f32 v198, v198
    v_exp_f32 v199, v199
    v_exp_f32 v200, v200
    v_exp_f32 v201, v201
    v_pk_mul_f32 v[178:179], v[178:179], v[186:187]
    v_pk_mul_f32 v[180:181], v[180:181], v[188:189]
    v_pk_mul_f32 v[182:183], v[182:183], v[190:191]
    v_pk_mul_f32 v[184:185], v[184:185], v[192:193]
    v_pk_fma_f32 v[194:195], v[194:195], v[140:141], v[140:141] op_sel:[0,0,0] op_sel_hi:[1,0,0]
    v_pk_fma_f32 v[196:197], v[196:197], v[140:141], v[140:141] op_sel:[0,0,0] op_sel_hi:[1,0,0]
    v_pk_fma_f32 v[198:199], v[198:199], v[142:143], v[142:143] op_sel:[0,0,0] op_sel_hi:[1,0,0]
    v_pk_fma_f32 v[200:201], v[200:201], v[142:143], v[142:143] op_sel:[0,0,0] op_sel_hi:[1,0,0]
    v_rcp_f32 v194, v194
    v_rcp_f32 v195, v195
    v_rcp_f32 v196, v196
    v_rcp_f32 v197, v197
    v_rcp_f32 v198, v198
    v_rcp_f32 v199, v199
    v_rcp_f32 v200, v200
    v_rcp_f32 v201, v201
    v_pk_mul_f32 v[178:179], v[178:179], v[194:195]
    v_pk_mul_f32 v[180:181], v[180:181], v[196:197]
    v_pk_mul_f32 v[182:183], v[182:183], v[198:199]
    v_pk_mul_f32 v[184:185], v[184:185], v[200:201]
    v_cvt_pk_bf16_f32 v208, v178, v179
    v_cvt_pk_bf16_f32 v209, v180, v181
    v_cvt_pk_bf16_f32 v210, v182, v183
    v_cvt_pk_bf16_f32 v211, v184, v185
    s_add_u32 s32, s34, s30
    buffer_store_dwordx4 v[208:211], v12, s[16:19], s32 offen sc1
    s_add_u32 s30, s28, 1024
    v_pk_fma_f32 v[178:179], v[152:153], v[128:129], v[48:49] op_sel:[0,0,0] op_sel_hi:[1,0,1]
    v_pk_fma_f32 v[180:181], v[154:155], v[128:129], v[50:51] op_sel:[0,0,0] op_sel_hi:[1,0,1]
    v_pk_fma_f32 v[182:183], v[152:153], v[130:131], v[52:53] op_sel:[0,0,0] op_sel_hi:[1,0,1]
    v_pk_fma_f32 v[184:185], v[154:155], v[130:131], v[54:55] op_sel:[0,0,0] op_sel_hi:[1,0,1]
    v_pk_fma_f32 v[186:187], v[156:157], v[128:129], v[64:65] op_sel:[0,0,0] op_sel_hi:[1,0,1]
    v_pk_fma_f32 v[188:189], v[158:159], v[128:129], v[66:67] op_sel:[0,0,0] op_sel_hi:[1,0,1]
    v_pk_fma_f32 v[190:191], v[156:157], v[130:131], v[68:69] op_sel:[0,0,0] op_sel_hi:[1,0,1]
    v_pk_fma_f32 v[192:193], v[158:159], v[130:131], v[70:71] op_sel:[0,0,0] op_sel_hi:[1,0,1]
    v_pk_mul_f32 v[194:195], v[178:179], v[128:129] op_sel:[0,1] op_sel_hi:[1,1]
    v_pk_mul_f32 v[196:197], v[180:181], v[128:129] op_sel:[0,1] op_sel_hi:[1,1]
    v_pk_mul_f32 v[198:199], v[182:183], v[130:131] op_sel:[0,1] op_sel_hi:[1,1]
    v_pk_mul_f32 v[200:201], v[184:185], v[130:131] op_sel:[0,1] op_sel_hi:[1,1]
    v_exp_f32 v194, v194
    v_exp_f32 v195, v195
    v_exp_f32 v196, v196
    v_exp_f32 v197, v197
    v_exp_f32 v198, v198
    v_exp_f32 v199, v199
    v_exp_f32 v200, v200
    v_exp_f32 v201, v201
    v_pk_mul_f32 v[178:179], v[178:179], v[186:187]
    v_pk_mul_f32 v[180:181], v[180:181], v[188:189]
    v_pk_mul_f32 v[182:183], v[182:183], v[190:191]
    v_pk_mul_f32 v[184:185], v[184:185], v[192:193]
    v_pk_fma_f32 v[194:195], v[194:195], v[136:137], v[136:137] op_sel:[0,0,0] op_sel_hi:[1,0,0]
    v_pk_fma_f32 v[196:197], v[196:197], v[136:137], v[136:137] op_sel:[0,0,0] op_sel_hi:[1,0,0]
    v_pk_fma_f32 v[198:199], v[198:199], v[138:139], v[138:139] op_sel:[0,0,0] op_sel_hi:[1,0,0]
    v_pk_fma_f32 v[200:201], v[200:201], v[138:139], v[138:139] op_sel:[0,0,0] op_sel_hi:[1,0,0]
    v_rcp_f32 v194, v194
    v_rcp_f32 v195, v195
    v_rcp_f32 v196, v196
    v_rcp_f32 v197, v197
    v_rcp_f32 v198, v198
    v_rcp_f32 v199, v199
    v_rcp_f32 v200, v200
    v_rcp_f32 v201, v201
    v_pk_mul_f32 v[178:179], v[178:179], v[194:195]
    v_pk_mul_f32 v[180:181], v[180:181], v[196:197]
    v_pk_mul_f32 v[182:183], v[182:183], v[198:199]
    v_pk_mul_f32 v[184:185], v[184:185], v[200:201]
    v_cvt_pk_bf16_f32 v204, v178, v179
    v_cvt_pk_bf16_f32 v205, v180, v181
    v_cvt_pk_bf16_f32 v206, v182, v183
    v_cvt_pk_bf16_f32 v207, v184, v185
    s_add_u32 s32, s33, s30
    buffer_store_dwordx4 v[204:207], v12, s[16:19], s32 offen sc1
    v_pk_fma_f32 v[178:179], v[152:153], v[132:133], v[56:57] op_sel:[0,0,0] op_sel_hi:[1,0,1]
    v_pk_fma_f32 v[180:181], v[154:155], v[132:133], v[58:59] op_sel:[0,0,0] op_sel_hi:[1,0,1]
    v_pk_fma_f32 v[182:183], v[152:153], v[134:135], v[60:61] op_sel:[0,0,0] op_sel_hi:[1,0,1]
    v_pk_fma_f32 v[184:185], v[154:155], v[134:135], v[62:63] op_sel:[0,0,0] op_sel_hi:[1,0,1]
    v_pk_fma_f32 v[186:187], v[156:157], v[132:133], v[72:73] op_sel:[0,0,0] op_sel_hi:[1,0,1]
    v_pk_fma_f32 v[188:189], v[158:159], v[132:133], v[74:75] op_sel:[0,0,0] op_sel_hi:[1,0,1]
    v_pk_fma_f32 v[190:191], v[156:157], v[134:135], v[76:77] op_sel:[0,0,0] op_sel_hi:[1,0,1]
    v_pk_fma_f32 v[192:193], v[158:159], v[134:135], v[78:79] op_sel:[0,0,0] op_sel_hi:[1,0,1]
    v_pk_mul_f32 v[194:195], v[178:179], v[132:133] op_sel:[0,1] op_sel_hi:[1,1]
    v_pk_mul_f32 v[196:197], v[180:181], v[132:133] op_sel:[0,1] op_sel_hi:[1,1]
    v_pk_mul_f32 v[198:199], v[182:183], v[134:135] op_sel:[0,1] op_sel_hi:[1,1]
    v_pk_mul_f32 v[200:201], v[184:185], v[134:135] op_sel:[0,1] op_sel_hi:[1,1]
    v_exp_f32 v194, v194
    v_exp_f32 v195, v195
    v_exp_f32 v196, v196
    v_exp_f32 v197, v197
    v_exp_f32 v198, v198
    v_exp_f32 v199, v199
    v_exp_f32 v200, v200
    v_exp_f32 v201, v201
    v_pk_mul_f32 v[178:179], v[178:179], v[186:187]
    v_pk_mul_f32 v[180:181], v[180:181], v[188:189]
    v_pk_mul_f32 v[182:183], v[182:183], v[190:191]
    v_pk_mul_f32 v[184:185], v[184:185], v[192:193]
    v_pk_fma_f32 v[194:195], v[194:195], v[140:141], v[140:141] op_sel:[0,0,0] op_sel_hi:[1,0,0]
    v_pk_fma_f32 v[196:197], v[196:197], v[140:141], v[140:141] op_sel:[0,0,0] op_sel_hi:[1,0,0]
    v_pk_fma_f32 v[198:199], v[198:199], v[142:143], v[142:143] op_sel:[0,0,0] op_sel_hi:[1,0,0]
    v_pk_fma_f32 v[200:201], v[200:201], v[142:143], v[142:143] op_sel:[0,0,0] op_sel_hi:[1,0,0]
    v_rcp_f32 v194, v194
    v_rcp_f32 v195, v195
    v_rcp_f32 v196, v196
    v_rcp_f32 v197, v197
    v_rcp_f32 v198, v198
    v_rcp_f32 v199, v199
    v_rcp_f32 v200, v200
    v_rcp_f32 v201, v201
    v_pk_mul_f32 v[178:179], v[178:179], v[194:195]
    v_pk_mul_f32 v[180:181], v[180:181], v[196:197]
    v_pk_mul_f32 v[182:183], v[182:183], v[198:199]
    v_pk_mul_f32 v[184:185], v[184:185], v[200:201]
    v_cvt_pk_bf16_f32 v208, v178, v179
    v_cvt_pk_bf16_f32 v209, v180, v181
    v_cvt_pk_bf16_f32 v210, v182, v183
    v_cvt_pk_bf16_f32 v211, v184, v185
    s_add_u32 s32, s34, s30
    buffer_store_dwordx4 v[208:211], v12, s[16:19], s32 offen sc1
    s_add_u32 s30, s28, 2048
    s_add_u32 s30, s30, s35
    v_pk_fma_f32 v[178:179], v[160:161], v[128:129], v[80:81] op_sel:[0,0,0] op_sel_hi:[1,0,1]
    v_pk_fma_f32 v[180:181], v[162:163], v[128:129], v[82:83] op_sel:[0,0,0] op_sel_hi:[1,0,1]
    v_pk_fma_f32 v[182:183], v[160:161], v[130:131], v[84:85] op_sel:[0,0,0] op_sel_hi:[1,0,1]
    v_pk_fma_f32 v[184:185], v[162:163], v[130:131], v[86:87] op_sel:[0,0,0] op_sel_hi:[1,0,1]
    v_pk_fma_f32 v[186:187], v[164:165], v[128:129], v[96:97] op_sel:[0,0,0] op_sel_hi:[1,0,1]
    v_pk_fma_f32 v[188:189], v[166:167], v[128:129], v[98:99] op_sel:[0,0,0] op_sel_hi:[1,0,1]
    v_pk_fma_f32 v[190:191], v[164:165], v[130:131], v[100:101] op_sel:[0,0,0] op_sel_hi:[1,0,1]
    v_pk_fma_f32 v[192:193], v[166:167], v[130:131], v[102:103] op_sel:[0,0,0] op_sel_hi:[1,0,1]
    v_pk_mul_f32 v[194:195], v[178:179], v[128:129] op_sel:[0,1] op_sel_hi:[1,1]
    v_pk_mul_f32 v[196:197], v[180:181], v[128:129] op_sel:[0,1] op_sel_hi:[1,1]
    v_pk_mul_f32 v[198:199], v[182:183], v[130:131] op_sel:[0,1] op_sel_hi:[1,1]
    v_pk_mul_f32 v[200:201], v[184:185], v[130:131] op_sel:[0,1] op_sel_hi:[1,1]
    v_exp_f32 v194, v194
    v_exp_f32 v195, v195
    v_exp_f32 v196, v196
    v_exp_f32 v197, v197
    v_exp_f32 v198, v198
    v_exp_f32 v199, v199
    v_exp_f32 v200, v200
    v_exp_f32 v201, v201
    v_pk_mul_f32 v[178:179], v[178:179], v[186:187]
    v_pk_mul_f32 v[180:181], v[180:181], v[188:189]
    v_pk_mul_f32 v[182:183], v[182:183], v[190:191]
    v_pk_mul_f32 v[184:185], v[184:185], v[192:193]
    v_pk_fma_f32 v[194:195], v[194:195], v[136:137], v[136:137] op_sel:[0,0,0] op_sel_hi:[1,0,0]
    v_pk_fma_f32 v[196:197], v[196:197], v[136:137], v[136:137] op_sel:[0,0,0] op_sel_hi:[1,0,0]
    v_pk_fma_f32 v[198:199], v[198:199], v[138:139], v[138:139] op_sel:[0,0,0] op_sel_hi:[1,0,0]
    v_pk_fma_f32 v[200:201], v[200:201], v[138:139], v[138:139] op_sel:[0,0,0] op_sel_hi:[1,0,0]
    v_rcp_f32 v194, v194
    v_rcp_f32 v195, v195
    v_rcp_f32 v196, v196
    v_rcp_f32 v197, v197
    v_rcp_f32 v198, v198
    v_rcp_f32 v199, v199
    v_rcp_f32 v200, v200
    v_rcp_f32 v201, v201
    v_pk_mul_f32 v[178:179], v[178:179], v[194:195]
    v_pk_mul_f32 v[180:181], v[180:181], v[196:197]
    v_pk_mul_f32 v[182:183], v[182:183], v[198:199]
    v_pk_mul_f32 v[184:185], v[184:185], v[200:201]
    v_cvt_pk_bf16_f32 v204, v178, v179
    v_cvt_pk_bf16_f32 v205, v180, v181
    v_cvt_pk_bf16_f32 v206, v182, v183
    v_cvt_pk_bf16_f32 v207, v184, v185
    s_add_u32 s32, s33, s30
    buffer_store_dwordx4 v[204:207], v12, s[16:19], s32 offen sc1
    v_pk_fma_f32 v[178:179], v[160:161], v[132:133], v[88:89] op_sel:[0,0,0] op_sel_hi:[1,0,1]
    v_pk_fma_f32 v[180:181], v[162:163], v[132:133], v[90:91] op_sel:[0,0,0] op_sel_hi:[1,0,1]
    v_pk_fma_f32 v[182:183], v[160:161], v[134:135], v[92:93] op_sel:[0,0,0] op_sel_hi:[1,0,1]
    v_pk_fma_f32 v[184:185], v[162:163], v[134:135], v[94:95] op_sel:[0,0,0] op_sel_hi:[1,0,1]
    v_pk_fma_f32 v[186:187], v[164:165], v[132:133], v[104:105] op_sel:[0,0,0] op_sel_hi:[1,0,1]
    v_pk_fma_f32 v[188:189], v[166:167], v[132:133], v[106:107] op_sel:[0,0,0] op_sel_hi:[1,0,1]
    v_pk_fma_f32 v[190:191], v[164:165], v[134:135], v[108:109] op_sel:[0,0,0] op_sel_hi:[1,0,1]
    v_pk_fma_f32 v[192:193], v[166:167], v[134:135], v[110:111] op_sel:[0,0,0] op_sel_hi:[1,0,1]
    v_pk_mul_f32 v[194:195], v[178:179], v[132:133] op_sel:[0,1] op_sel_hi:[1,1]
    v_pk_mul_f32 v[196:197], v[180:181], v[132:133] op_sel:[0,1] op_sel_hi:[1,1]
    v_pk_mul_f32 v[198:199], v[182:183], v[134:135] op_sel:[0,1] op_sel_hi:[1,1]
    v_pk_mul_f32 v[200:201], v[184:185], v[134:135] op_sel:[0,1] op_sel_hi:[1,1]
    v_exp_f32 v194, v194
    v_exp_f32 v195, v195
    v_exp_f32 v196, v196
    v_exp_f32 v197, v197
    v_exp_f32 v198, v198
    v_exp_f32 v199, v199
    v_exp_f32 v200, v200
    v_exp_f32 v201, v201
    v_pk_mul_f32 v[178:179], v[178:179], v[186:187]
    v_pk_mul_f32 v[180:181], v[180:181], v[188:189]
    v_pk_mul_f32 v[182:183], v[182:183], v[190:191]
    v_pk_mul_f32 v[184:185], v[184:185], v[192:193]
    v_pk_fma_f32 v[194:195], v[194:195], v[140:141], v[140:141] op_sel:[0,0,0] op_sel_hi:[1,0,0]
    v_pk_fma_f32 v[196:197], v[196:197], v[140:141], v[140:141] op_sel:[0,0,0] op_sel_hi:[1,0,0]
    v_pk_fma_f32 v[198:199], v[198:199], v[142:143], v[142:143] op_sel:[0,0,0] op_sel_hi:[1,0,0]
    v_pk_fma_f32 v[200:201], v[200:201], v[142:143], v[142:143] op_sel:[0,0,0] op_sel_hi:[1,0,0]
    v_rcp_f32 v194, v194
    v_rcp_f32 v195, v195
    v_rcp_f32 v196, v196
    v_rcp_f32 v197, v197
    v_rcp_f32 v198, v198
    v_rcp_f32 v199, v199
    v_rcp_f32 v200, v200
    v_rcp_f32 v201, v201
    v_pk_mul_f32 v[178:179], v[178:179], v[194:195]
    v_pk_mul_f32 v[180:181], v[180:181], v[196:197]
    v_pk_mul_f32 v[182:183], v[182:183], v[198:199]
    v_pk_mul_f32 v[184:185], v[184:185], v[200:201]
    v_cvt_pk_bf16_f32 v208, v178, v179
    v_cvt_pk_bf16_f32 v209, v180, v181
    v_cvt_pk_bf16_f32 v210, v182, v183
    v_cvt_pk_bf16_f32 v211, v184, v185
    s_add_u32 s32, s34, s30
    buffer_store_dwordx4 v[208:211], v12, s[16:19], s32 offen sc1
    s_movk_i32 s30, 3072
    v_pk_fma_f32 v[178:179], v[168:169], v[128:129], v[112:113] op_sel:[0,0,0] op_sel_hi:[1,0,1]
    v_pk_fma_f32 v[180:181], v[170:171], v[128:129], v[114:115] op_sel:[0,0,0] op_sel_hi:[1,0,1]
    v_pk_fma_f32 v[182:183], v[168:169], v[130:131], v[116:117] op_sel:[0,0,0] op_sel_hi:[1,0,1]
    v_pk_fma_f32 v[184:185], v[170:171], v[130:131], v[118:119] op_sel:[0,0,0] op_sel_hi:[1,0,1]
    v_pk_fma_f32 v[186:187], v[172:173], v[128:129], v[120:121] op_sel:[0,0,0] op_sel_hi:[1,0,1]
    v_pk_fma_f32 v[188:189], v[174:175], v[128:129], v[122:123] op_sel:[0,0,0] op_sel_hi:[1,0,1]
    v_pk_fma_f32 v[190:191], v[172:173], v[130:131], v[124:125] op_sel:[0,0,0] op_sel_hi:[1,0,1]
    v_pk_fma_f32 v[192:193], v[174:175], v[130:131], v[126:127] op_sel:[0,0,0] op_sel_hi:[1,0,1]
    v_pk_mul_f32 v[194:195], v[178:179], v[128:129] op_sel:[0,1] op_sel_hi:[1,1]
    v_pk_mul_f32 v[196:197], v[180:181], v[128:129] op_sel:[0,1] op_sel_hi:[1,1]
    v_pk_mul_f32 v[198:199], v[182:183], v[130:131] op_sel:[0,1] op_sel_hi:[1,1]
    v_pk_mul_f32 v[200:201], v[184:185], v[130:131] op_sel:[0,1] op_sel_hi:[1,1]
    v_exp_f32 v194, v194
    v_exp_f32 v195, v195
    v_exp_f32 v196, v196
    v_exp_f32 v197, v197
    v_exp_f32 v198, v198
    v_exp_f32 v199, v199
    v_exp_f32 v200, v200
    v_exp_f32 v201, v201
    v_pk_mul_f32 v[178:179], v[178:179], v[186:187]
    v_pk_mul_f32 v[180:181], v[180:181], v[188:189]
    v_pk_mul_f32 v[182:183], v[182:183], v[190:191]
    v_pk_mul_f32 v[184:185], v[184:185], v[192:193]
    v_pk_fma_f32 v[194:195], v[194:195], v[136:137], v[136:137] op_sel:[0,0,0] op_sel_hi:[1,0,0]
    v_pk_fma_f32 v[196:197], v[196:197], v[136:137], v[136:137] op_sel:[0,0,0] op_sel_hi:[1,0,0]
    v_pk_fma_f32 v[198:199], v[198:199], v[138:139], v[138:139] op_sel:[0,0,0] op_sel_hi:[1,0,0]
    v_pk_fma_f32 v[200:201], v[200:201], v[138:139], v[138:139] op_sel:[0,0,0] op_sel_hi:[1,0,0]
    v_rcp_f32 v194, v194
    v_rcp_f32 v195, v195
    v_rcp_f32 v196, v196
    v_rcp_f32 v197, v197
    v_rcp_f32 v198, v198
    v_rcp_f32 v199, v199
    v_rcp_f32 v200, v200
    v_rcp_f32 v201, v201
    v_pk_mul_f32 v[178:179], v[178:179], v[194:195]
    v_pk_mul_f32 v[180:181], v[180:181], v[196:197]
    v_pk_mul_f32 v[182:183], v[182:183], v[198:199]
    v_pk_mul_f32 v[184:185], v[184:185], v[200:201]
    v_cvt_pk_bf16_f32 v204, v178, v179
    v_cvt_pk_bf16_f32 v205, v180, v181
    v_cvt_pk_bf16_f32 v206, v182, v183
    v_cvt_pk_bf16_f32 v207, v184, v185
    s_add_u32 s32, s33, s30
    buffer_store_dwordx4 v[204:207], v12, s[16:19], s32 offen sc1
    s_mov_b32 s95, s25
    s_waitcnt vmcnt(0)
    s_barrier
    s_and_b32 s29, s2, 7
    s_lshr_b32 s30, s2, 3
    s_lshl_b32 s25, s29, 2
    s_and_b32 s26, s30, 3
    s_add_u32 s25, s25, s26
    s_lshr_b32 s26, s30, 2
    s_lshr_b32 s87, s25, 1
    s_cmp_eq_u32 s24, 0
    s_cbranch_scc0 L_aw_adone_f
    s_lshl_b32 s84, s95, 8
    v_mov_b32 v6, s84
    v_mov_b32 v8, 1
    s_mov_b64 exec, 1
    buffer_atomic_add v8, v6, s[88:91], 0 offen offset:0 sc0 sc1
    s_waitcnt vmcnt(0)
    v_readfirstlane_b32 s85, v8
    s_nop 0
    s_cmp_eq_u32 s85, 15
    s_cbranch_scc0 L_aw_notlast_f
    v_mov_b32 v8, 1
    buffer_store_dword v8, v6, s[88:91], 0 offen offset:128 sc1
L_aw_notlast_f:
    s_mov_b64 exec, -1
L_aw_adone_f:
    s_add_u32 s8, s6, 28311552
    s_addc_u32 s9, s7, 0
    s_mov_b32 s10, 2211840
    s_mov_b32 s11, 131072
    s_add_u32 s12, s6, 9437184
    s_addc_u32 s13, s7, 0
    s_mov_b32 s14, 7077888
    s_mov_b32 s15, 131072
    s_add_u32 s16, s6, 6291456
    s_addc_u32 s17, s7, 0
    s_mov_b32 s18, 2621440
    s_mov_b32 s19, 131072
    s_mov_b32 s20, s92
    s_mov_b32 s21, s93
    s_mov_b32 s22, 2621440
    s_mov_b32 s23, 131072
    v_lshrrev_b32 v6, 4, v1
    v_lshlrev_b32 v2, 4, v1
    s_lshr_b32 s29, s24, 1
    s_mul_i32 s30, s29, 5120
    s_and_b32 s28, s24, 1
    s_lshl_b32 s33, s25, 1
    s_add_u32 s33, s33, s28
    s_mul_i32 s33, s33, 110592
    v_add_u32 v5, s33, v2
    v_add_u32 v2, s30, v2
    s_lshl_b32 s31, s29, 11
    s_lshl_b32 s33, s25, 6
    s_lshl_b32 s28, s28, 5
    s_add_u32 s33, s33, s28
    s_lshl_b32 s29, s29, 4
    s_add_u32 s33, s33, s29
    v_and_b32 v9, 15, v1
    v_add_u32 v9, s33, v9
    s_mul_i32 s29, s26, 20
    v_add_u32 v10, s29, v6
    v_lshlrev_b32 v10, 14, v10
    v_lshl_add_u32 v10, v9, 3, v10
    s_mov_b32 s29, 0
    buffer_load_dwordx2 v[200:201], v10, s[16:19], s29 offen
    s_mov_b32 s29, 65536
    buffer_load_dwordx2 v[202:203], v10, s[16:19], s29 offen
    s_mov_b32 s29, 131072
    buffer_load_dwordx2 v[204:205], v10, s[16:19], s29 offen
    s_mov_b32 s29, 196608
    buffer_load_dwordx2 v[206:207], v10, s[16:19], s29 offen
    s_mov_b32 s29, 262144
    buffer_load_dwordx2 v[208:209], v10, s[16:19], s29 offen
    s_movk_i32 s29, 1280
    v_mul_lo_u32 v11, v9, s29
    s_mul_i32 s29, s26, 160
    v_lshl_add_u32 v11, v6, 3, v11
    v_add_u32 v11, s29, v11
    v_mov_b32 v16, 0
    v_mov_b32 v17, 0
    v_mov_b32 v18, 0
    v_mov_b32 v19, 0
    v_mov_b32 v20, 0
    v_mov_b32 v21, 0
    v_mov_b32 v22, 0
    v_mov_b32 v23, 0
    v_mov_b32 v24, 0
    v_mov_b32 v25, 0
    v_mov_b32 v26, 0
    v_mov_b32 v27, 0
    v_mov_b32 v28, 0
    v_mov_b32 v29, 0
    v_mov_b32 v30, 0
    v_mov_b32 v31, 0
    v_mov_b32 v32, 0
    v_mov_b32 v33, 0
    v_mov_b32 v34, 0
    v_mov_b32 v35, 0
    v_mov_b32 v36, 0
    v_mov_b32 v37, 0
    v_mov_b32 v38, 0
    v_mov_b32 v39, 0
    v_mov_b32 v40, 0
    v_mov_b32 v41, 0
    v_mov_b32 v42, 0
    v_mov_b32 v43, 0
    v_mov_b32 v44, 0
    v_mov_b32 v45, 0
    v_mov_b32 v46, 0
    v_mov_b32 v47, 0
    v_mov_b32 v48, 0
    v_mov_b32 v49, 0
    v_mov_b32 v50, 0
    v_mov_b32 v51, 0
    v_mov_b32 v52, 0
    v_mov_b32 v53, 0
    v_mov_b32 v54, 0
    v_mov_b32 v55, 0
    s_cmp_eq_u32 s24, 0
    s_cbranch_scc0 L_aw_done_f
    s_lshl_b32 s84, s87, 8
    v_mov_b32 v6, s84
    s_mov_b32 s85, 0
    s_mov_b64 exec, 1
L_aw_poll_f:
    buffer_load_dword v8, v6, s[88:91], 0 offen offset:128 sc1
    s_waitcnt vmcnt(0)
    v_readfirstlane_b32 s94, v8
    s_nop 0
    s_cmp_lg_u32 s94, 0
    s_cbranch_scc1 L_aw_ok_f
    s_add_u32 s85, s85, 1
    s_cmp_lt_u32 s85, 200000
    s_cbranch_scc1 L_aw_poll_f
L_aw_ok_f:
    s_mov_b64 exec, -1
L_aw_done_f:
    s_barrier
    buffer_load_dwordx4 v[96:99], v5, s[12:15], s31 offen sc1
    buffer_load_dwordx4 v[100:103], v5, s[12:15], s31 offen offset:1024 sc1
    s_add_u32 s31, s31, 4096
    buffer_load_dwordx4 v[104:107], v5, s[12:15], s31 offen sc1
    buffer_load_dwordx4 v[108:111], v5, s[12:15], s31 offen offset:1024 sc1
    s_add_u32 s31, s31, 4096
    buffer_load_dwordx4 v[112:115], v5, s[12:15], s31 offen sc1
    buffer_load_dwordx4 v[116:119], v5, s[12:15], s31 offen offset:1024 sc1
    s_add_u32 s31, s31, 4096
    buffer_load_dwordx4 v[120:123], v5, s[12:15], s31 offen sc1
    buffer_load_dwordx4 v[124:127], v5, s[12:15], s31 offen offset:1024 sc1
    s_add_u32 s31, s31, 4096
    buffer_load_dwordx4 v[128:131], v5, s[12:15], s31 offen sc1
    buffer_load_dwordx4 v[132:135], v5, s[12:15], s31 offen offset:1024 sc1
    s_add_u32 s31, s31, 4096
    buffer_load_dwordx4 v[136:139], v5, s[12:15], s31 offen sc1
    buffer_load_dwordx4 v[140:143], v5, s[12:15], s31 offen offset:1024 sc1
    s_add_u32 s31, s31, 4096
    s_mov_b32 s27, 0
    v_mov_b32 v4, v2
    ds_read_b128 v[56:59], v4 offset:0
    ds_read_b128 v[60:63], v4 offset:1024
    ds_read_b128 v[64:67], v4 offset:2048
    ds_read_b128 v[68:71], v4 offset:3072
    ds_read_b128 v[72:75], v4 offset:4096
    s_mov_b32 s28, 0
L_g2n_c_f:
    s_barrier
    s_waitcnt vmcnt(10) lgkmcnt(0)
    v_swap_b32 v98, v100
    v_swap_b32 v99, v101
    ds_read_b128 v[76:79], v4 offset:10240
    s_nop 0
    v_mfma_f32_16x16x32_bf16 v[16:19], v[56:59], v[96:99], v[16:19]
    ds_read_b128 v[80:83], v4 offset:11264
    v_mfma_f32_16x16x32_bf16 v[36:39], v[56:59], v[100:103], v[36:39]
    ds_read_b128 v[84:87], v4 offset:12288
    v_mfma_f32_16x16x32_bf16 v[20:23], v[60:63], v[96:99], v[20:23]
    ds_read_b128 v[88:91], v4 offset:13312
    v_mfma_f32_16x16x32_bf16 v[40:43], v[60:63], v[100:103], v[40:43]
    ds_read_b128 v[92:95], v4 offset:14336
    v_mfma_f32_16x16x32_bf16 v[24:27], v[64:67], v[96:99], v[24:27]
    v_mfma_f32_16x16x32_bf16 v[44:47], v[64:67], v[100:103], v[44:47]
    v_mfma_f32_16x16x32_bf16 v[28:31], v[68:71], v[96:99], v[28:31]
    v_mfma_f32_16x16x32_bf16 v[48:51], v[68:71], v[100:103], v[48:51]
    v_mfma_f32_16x16x32_bf16 v[32:35], v[72:75], v[96:99], v[32:35]
    v_mfma_f32_16x16x32_bf16 v[52:55], v[72:75], v[100:103], v[52:55]
    buffer_load_dwordx4 v[96:99], v5, s[12:15], s31 offen sc1
    buffer_load_dwordx4 v[100:103], v5, s[12:15], s31 offen offset:1024 sc1
    s_add_u32 s31, s31, 4096
    s_add_u32 s27, s27, 20480
    s_sub_u32 s29, s27, 143360
    s_cmp_ge_u32 s27, 143360
    s_cselect_b32 s27, s29, s27
    v_add_u32 v4, s27, v2
    s_waitcnt vmcnt(10) lgkmcnt(0)
    v_swap_b32 v106, v108
    v_swap_b32 v107, v109
    ds_read_b128 v[56:59], v4 offset:0
    s_nop 0
    v_mfma_f32_16x16x32_bf16 v[16:19], v[76:79], v[104:107], v[16:19]
    ds_read_b128 v[60:63], v4 offset:1024
    v_mfma_f32_16x16x32_bf16 v[36:39], v[76:79], v[108:111], v[36:39]
    ds_read_b128 v[64:67], v4 offset:2048
    v_mfma_f32_16x16x32_bf16 v[20:23], v[80:83], v[104:107], v[20:23]
    ds_read_b128 v[68:71], v4 offset:3072
    v_mfma_f32_16x16x32_bf16 v[40:43], v[80:83], v[108:111], v[40:43]
    ds_read_b128 v[72:75], v4 offset:4096
    v_mfma_f32_16x16x32_bf16 v[24:27], v[84:87], v[104:107], v[24:27]
    v_mfma_f32_16x16x32_bf16 v[44:47], v[84:87], v[108:111], v[44:47]
    v_mfma_f32_16x16x32_bf16 v[28:31], v[88:91], v[104:107], v[28:31]
    v_mfma_f32_16x16x32_bf16 v[48:51], v[88:91], v[108:111], v[48:51]
    v_mfma_f32_16x16x32_bf16 v[32:35], v[92:95], v[104:107], v[32:35]
    v_mfma_f32_16x16x32_bf16 v[52:55], v[92:95], v[108:111], v[52:55]
    buffer_load_dwordx4 v[104:107], v5, s[12:15], s31 offen sc1
    buffer_load_dwordx4 v[108:111], v5, s[12:15], s31 offen offset:1024 sc1
    s_add_u32 s31, s31, 4096
    s_barrier
    s_waitcnt vmcnt(10) lgkmcnt(0)
    v_swap_b32 v114, v116
    v_swap_b32 v115, v117
    ds_read_b128 v[76:79], v4 offset:10240
    s_nop 0
    v_mfma_f32_16x16x32_bf16 v[16:19], v[56:59], v[112:115], v[16:19]
    ds_read_b128 v[80:83], v4 offset:11264
    v_mfma_f32_16x16x32_bf16 v[36:39], v[56:59], v[116:119], v[36:39]
    ds_read_b128 v[84:87], v4 offset:12288
    v_mfma_f32_16x16x32_bf16 v[20:23], v[60:63], v[112:115], v[20:23]
    ds_read_b128 v[88:91], v4 offset:13312
    v_mfma_f32_16x16x32_bf16 v[40:43], v[60:63], v[116:119], v[40:43]
    ds_read_b128 v[92:95], v4 offset:14336
    v_mfma_f32_16x16x32_bf16 v[24:27], v[64:67], v[112:115], v[24:27]
    v_mfma_f32_16x16x32_bf16 v[44:47], v[64:67], v[116:119], v[44:47]
    v_mfma_f32_16x16x32_bf16 v[28:31], v[68:71], v[112:115], v[28:31]
    v_mfma_f32_16x16x32_bf16 v[48:51], v[68:71], v[116:119], v[48:51]
    v_mfma_f32_16x16x32_bf16 v[32:35], v[72:75], v[112:115], v[32:35]
    v_mfma_f32_16x16x32_bf16 v[52:55], v[72:75], v[116:119], v[52:55]
    buffer_load_dwordx4 v[112:115], v5, s[12:15], s31 offen sc1
    buffer_load_dwordx4 v[116:119], v5, s[12:15], s31 offen offset:1024 sc1
    s_add_u32 s31, s31, 4096
    s_add_u32 s27, s27, 20480
    s_sub_u32 s29, s27, 143360
    s_cmp_ge_u32 s27, 143360
    s_cselect_b32 s27, s29, s27
    v_add_u32 v4, s27, v2
    s_waitcnt vmcnt(10) lgkmcnt(0)
    v_swap_b32 v122, v124
    v_swap_b32 v123, v125
    ds_read_b128 v[56:59], v4 offset:0
    s_nop 0
    v_mfma_f32_16x16x32_bf16 v[16:19], v[76:79], v[120:123], v[16:19]
    ds_read_b128 v[60:63], v4 offset:1024
    v_mfma_f32_16x16x32_bf16 v[36:39], v[76:79], v[124:127], v[36:39]
    ds_read_b128 v[64:67], v4 offset:2048
    v_mfma_f32_16x16x32_bf16 v[20:23], v[80:83], v[120:123], v[20:23]
    ds_read_b128 v[68:71], v4 offset:3072
    v_mfma_f32_16x16x32_bf16 v[40:43], v[80:83], v[124:127], v[40:43]
    ds_read_b128 v[72:75], v4 offset:4096
    v_mfma_f32_16x16x32_bf16 v[24:27], v[84:87], v[120:123], v[24:27]
    v_mfma_f32_16x16x32_bf16 v[44:47], v[84:87], v[124:127], v[44:47]
    v_mfma_f32_16x16x32_bf16 v[28:31], v[88:91], v[120:123], v[28:31]
    v_mfma_f32_16x16x32_bf16 v[48:51], v[88:91], v[124:127], v[48:51]
    v_mfma_f32_16x16x32_bf16 v[32:35], v[92:95], v[120:123], v[32:35]
    v_mfma_f32_16x16x32_bf16 v[52:55], v[92:95], v[124:127], v[52:55]
    buffer_load_dwordx4 v[120:123], v5, s[12:15], s31 offen sc1
    buffer_load_dwordx4 v[124:127], v5, s[12:15], s31 offen offset:1024 sc1
    s_add_u32 s31, s31, 4096
    s_barrier
    s_waitcnt vmcnt(10) lgkmcnt(0)
    v_swap_b32 v130, v132
    v_swap_b32 v131, v133
    ds_read_b128 v[76:79], v4 offset:10240
    s_nop 0
    v_mfma_f32_16x16x32_bf16 v[16:19], v[56:59], v[128:131], v[16:19]
    ds_read_b128 v[80:83], v4 offset:11264
    v_mfma_f32_16x16x32_bf16 v[36:39], v[56:59], v[132:135], v[36:39]
    ds_read_b128 v[84:87], v4 offset:12288
    v_mfma_f32_16x16x32_bf16 v[20:23], v[60:63], v[128:131], v[20:23]
    ds_read_b128 v[88:91], v4 offset:13312
    v_mfma_f32_16x16x32_bf16 v[40:43], v[60:63], v[132:135], v[40:43]
    ds_read_b128 v[92:95], v4 offset:14336
    v_mfma_f32_16x16x32_bf16 v[24:27], v[64:67], v[128:131], v[24:27]
    v_mfma_f32_16x16x32_bf16 v[44:47], v[64:67], v[132:135], v[44:47]
    v_mfma_f32_16x16x32_bf16 v[28:31], v[68:71], v[128:131], v[28:31]
    v_mfma_f32_16x16x32_bf16 v[48:51], v[68:71], v[132:135], v[48:51]
    v_mfma_f32_16x16x32_bf16 v[32:35], v[72:75], v[128:131], v[32:35]
    v_mfma_f32_16x16x32_bf16 v[52:55], v[72:75], v[132:135], v[52:55]
    buffer_load_dwordx4 v[128:131], v5, s[12:15], s31 offen sc1
    buffer_load_dwordx4 v[132:135], v5, s[12:15], s31 offen offset:1024 sc1
    s_add_u32 s31, s31, 4096
    s_add_u32 s27, s27, 20480
    s_sub_u32 s29, s27, 143360
    s_cmp_ge_u32 s27, 143360
    s_cselect_b32 s27, s29, s27
    v_add_u32 v4, s27, v2
    s_waitcnt vmcnt(10) lgkmcnt(0)
    v_swap_b32 v138, v140
    v_swap_b32 v139, v141
    ds_read_b128 v[56:59], v4 offset:0
    s_nop 0
    v_mfma_f32_16x16x32_bf16 v[16:19], v[76:79], v[136:139], v[16:19]
    ds_read_b128 v[60:63], v4 offset:1024
    v_mfma_f32_16x16x32_bf16 v[36:39], v[76:79], v[140:143], v[36:39]
    ds_read_b128 v[64:67], v4 offset:2048
    v_mfma_f32_16x16x32_bf16 v[20:23], v[80:83], v[136:139], v[20:23]
    ds_read_b128 v[68:71], v4 offset:3072
    v_mfma_f32_16x16x32_bf16 v[40:43], v[80:83], v[140:143], v[40:43]
    ds_read_b128 v[72:75], v4 offset:4096
    v_mfma_f32_16x16x32_bf16 v[24:27], v[84:87], v[136:139], v[24:27]
    v_mfma_f32_16x16x32_bf16 v[44:47], v[84:87], v[140:143], v[44:47]
    v_mfma_f32_16x16x32_bf16 v[28:31], v[88:91], v[136:139], v[28:31]
    v_mfma_f32_16x16x32_bf16 v[48:51], v[88:91], v[140:143], v[48:51]
    v_mfma_f32_16x16x32_bf16 v[32:35], v[92:95], v[136:139], v[32:35]
    v_mfma_f32_16x16x32_bf16 v[52:55], v[92:95], v[140:143], v[52:55]
    buffer_load_dwordx4 v[136:139], v5, s[12:15], s31 offen sc1
    buffer_load_dwordx4 v[140:143], v5, s[12:15], s31 offen offset:1024 sc1
    s_add_u32 s31, s31, 4096
    s_add_u32 s28, s28, 1
    s_cmp_lt_u32 s28, 3
    s_cbranch_scc1 L_g2n_c_f
    s_barrier
    s_waitcnt vmcnt(10) lgkmcnt(0)
    v_swap_b32 v98, v100
    v_swap_b32 v99, v101
    ds_read_b128 v[76:79], v4 offset:10240
    s_nop 0
    v_mfma_f32_16x16x32_bf16 v[16:19], v[56:59], v[96:99], v[16:19]
    ds_read_b128 v[80:83], v4 offset:11264
    v_mfma_f32_16x16x32_bf16 v[36:39], v[56:59], v[100:103], v[36:39]
    ds_read_b128 v[84:87], v4 offset:12288
    v_mfma_f32_16x16x32_bf16 v[20:23], v[60:63], v[96:99], v[20:23]
    ds_read_b128 v[88:91], v4 offset:13312
    v_mfma_f32_16x16x32_bf16 v[40:43], v[60:63], v[100:103], v[40:43]
    ds_read_b128 v[92:95], v4 offset:14336
    v_mfma_f32_16x16x32_bf16 v[24:27], v[64:67], v[96:99], v[24:27]
    v_mfma_f32_16x16x32_bf16 v[44:47], v[64:67], v[100:103], v[44:47]
    v_mfma_f32_16x16x32_bf16 v[28:31], v[68:71], v[96:99], v[28:31]
    v_mfma_f32_16x16x32_bf16 v[48:51], v[68:71], v[100:103], v[48:51]
    v_mfma_f32_16x16x32_bf16 v[32:35], v[72:75], v[96:99], v[32:35]
    v_mfma_f32_16x16x32_bf16 v[52:55], v[72:75], v[100:103], v[52:55]
    buffer_load_dwordx4 v[96:99], v5, s[12:15], s31 offen sc1
    buffer_load_dwordx4 v[100:103], v5, s[12:15], s31 offen offset:1024 sc1
    s_add_u32 s31, s31, 4096
    s_add_u32 s27, s27, 20480
    s_sub_u32 s29, s27, 143360
    s_cmp_ge_u32 s27, 143360
    s_cselect_b32 s27, s29, s27
    v_add_u32 v4, s27, v2
    s_waitcnt vmcnt(10) lgkmcnt(0)
    v_swap_b32 v106, v108
    v_swap_b32 v107, v109
    ds_read_b128 v[56:59], v4 offset:0
    s_nop 0
    v_mfma_f32_16x16x32_bf16 v[16:19], v[76:79], v[104:107], v[16:19]
    ds_read_b128 v[60:63], v4 offset:1024
    v_mfma_f32_16x16x32_bf16 v[36:39], v[76:79], v[108:111], v[36:39]
    ds_read_b128 v[64:67], v4 offset:2048
    v_mfma_f32_16x16x32_bf16 v[20:23], v[80:83], v[104:107], v[20:23]
    ds_read_b128 v[68:71], v4 offset:3072
    v_mfma_f32_16x16x32_bf16 v[40:43], v[80:83], v[108:111], v[40:43]
    ds_read_b128 v[72:75], v4 offset:4096
    v_mfma_f32_16x16x32_bf16 v[24:27], v[84:87], v[104:107], v[24:27]
    v_mfma_f32_16x16x32_bf16 v[44:47], v[84:87], v[108:111], v[44:47]
    v_mfma_f32_16x16x32_bf16 v[28:31], v[88:91], v[104:107], v[28:31]
    v_mfma_f32_16x16x32_bf16 v[48:51], v[88:91], v[108:111], v[48:51]
    v_mfma_f32_16x16x32_bf16 v[32:35], v[92:95], v[104:107], v[32:35]
    v_mfma_f32_16x16x32_bf16 v[52:55], v[92:95], v[108:111], v[52:55]
    buffer_load_dwordx4 v[104:107], v5, s[12:15], s31 offen sc1
    buffer_load_dwordx4 v[108:111], v5, s[12:15], s31 offen offset:1024 sc1
    s_add_u32 s31, s31, 4096
    s_barrier
    s_waitcnt vmcnt(10) lgkmcnt(0)
    v_swap_b32 v114, v116
    v_swap_b32 v115, v117
    ds_read_b128 v[76:79], v4 offset:10240
    s_nop 0
    v_mfma_f32_16x16x32_bf16 v[16:19], v[56:59], v[112:115], v[16:19]
    ds_read_b128 v[80:83], v4 offset:11264
    v_mfma_f32_16x16x32_bf16 v[36:39], v[56:59], v[116:119], v[36:39]
    ds_read_b128 v[84:87], v4 offset:12288
    v_mfma_f32_16x16x32_bf16 v[20:23], v[60:63], v[112:115], v[20:23]
    ds_read_b128 v[88:91], v4 offset:13312
    v_mfma_f32_16x16x32_bf16 v[40:43], v[60:63], v[116:119], v[40:43]
    ds_read_b128 v[92:95], v4 offset:14336
    v_mfma_f32_16x16x32_bf16 v[24:27], v[64:67], v[112:115], v[24:27]
    v_mfma_f32_16x16x32_bf16 v[44:47], v[64:67], v[116:119], v[44:47]
    v_mfma_f32_16x16x32_bf16 v[28:31], v[68:71], v[112:115], v[28:31]
    v_mfma_f32_16x16x32_bf16 v[48:51], v[68:71], v[116:119], v[48:51]
    v_mfma_f32_16x16x32_bf16 v[32:35], v[72:75], v[112:115], v[32:35]
    v_mfma_f32_16x16x32_bf16 v[52:55], v[72:75], v[116:119], v[52:55]
    buffer_load_dwordx4 v[112:115], v5, s[12:15], s31 offen sc1
    buffer_load_dwordx4 v[116:119], v5, s[12:15], s31 offen offset:1024 sc1
    s_add_u32 s31, s31, 4096
    s_add_u32 s27, s27, 20480
    s_sub_u32 s29, s27, 143360
    s_cmp_ge_u32 s27, 143360
    s_cselect_b32 s27, s29, s27
    v_add_u32 v4, s27, v2
    s_waitcnt vmcnt(10) lgkmcnt(0)
    v_swap_b32 v122, v124
    v_swap_b32 v123, v125
    ds_read_b128 v[56:59], v4 offset:0
    s_nop 0
    v_mfma_f32_16x16x32_bf16 v[16:19], v[76:79], v[120:123], v[16:19]
    ds_read_b128 v[60:63], v4 offset:1024
    v_mfma_f32_16x16x32_bf16 v[36:39], v[76:79], v[124:127], v[36:39]
    ds_read_b128 v[64:67], v4 offset:2048
    v_mfma_f32_16x16x32_bf16 v[20:23], v[80:83], v[120:123], v[20:23]
    ds_read_b128 v[68:71], v4 offset:3072
    v_mfma_f32_16x16x32_bf16 v[40:43], v[80:83], v[124:127], v[40:43]
    ds_read_b128 v[72:75], v4 offset:4096
    v_mfma_f32_16x16x32_bf16 v[24:27], v[84:87], v[120:123], v[24:27]
    v_mfma_f32_16x16x32_bf16 v[44:47], v[84:87], v[124:127], v[44:47]
    v_mfma_f32_16x16x32_bf16 v[28:31], v[88:91], v[120:123], v[28:31]
    v_mfma_f32_16x16x32_bf16 v[48:51], v[88:91], v[124:127], v[48:51]
    v_mfma_f32_16x16x32_bf16 v[32:35], v[92:95], v[120:123], v[32:35]
    v_mfma_f32_16x16x32_bf16 v[52:55], v[92:95], v[124:127], v[52:55]
    s_barrier
    s_waitcnt vmcnt(8) lgkmcnt(0)
    v_swap_b32 v130, v132
    v_swap_b32 v131, v133
    ds_read_b128 v[76:79], v4 offset:10240
    s_nop 0
    v_mfma_f32_16x16x32_bf16 v[16:19], v[56:59], v[128:131], v[16:19]
    ds_read_b128 v[80:83], v4 offset:11264
    v_mfma_f32_16x16x32_bf16 v[36:39], v[56:59], v[132:135], v[36:39]
    ds_read_b128 v[84:87], v4 offset:12288
    v_mfma_f32_16x16x32_bf16 v[20:23], v[60:63], v[128:131], v[20:23]
    ds_read_b128 v[88:91], v4 offset:13312
    v_mfma_f32_16x16x32_bf16 v[40:43], v[60:63], v[132:135], v[40:43]
    ds_read_b128 v[92:95], v4 offset:14336
    v_mfma_f32_16x16x32_bf16 v[24:27], v[64:67], v[128:131], v[24:27]
    v_mfma_f32_16x16x32_bf16 v[44:47], v[64:67], v[132:135], v[44:47]
    v_mfma_f32_16x16x32_bf16 v[28:31], v[68:71], v[128:131], v[28:31]
    v_mfma_f32_16x16x32_bf16 v[48:51], v[68:71], v[132:135], v[48:51]
    v_mfma_f32_16x16x32_bf16 v[32:35], v[72:75], v[128:131], v[32:35]
    v_mfma_f32_16x16x32_bf16 v[52:55], v[72:75], v[132:135], v[52:55]
    s_add_u32 s27, s27, 20480
    s_sub_u32 s29, s27, 143360
    s_cmp_ge_u32 s27, 143360
    s_cselect_b32 s27, s29, s27
    v_add_u32 v4, s27, v2
    s_waitcnt vmcnt(6) lgkmcnt(0)
    v_swap_b32 v138, v140
    v_swap_b32 v139, v141
    ds_read_b128 v[56:59], v4 offset:0
    s_nop 0
    v_mfma_f32_16x16x32_bf16 v[16:19], v[76:79], v[136:139], v[16:19]
    ds_read_b128 v[60:63], v4 offset:1024
    v_mfma_f32_16x16x32_bf16 v[36:39], v[76:79], v[140:143], v[36:39]
    ds_read_b128 v[64:67], v4 offset:2048
    v_mfma_f32_16x16x32_bf16 v[20:23], v[80:83], v[136:139], v[20:23]
    ds_read_b128 v[68:71], v4 offset:3072
    v_mfma_f32_16x16x32_bf16 v[40:43], v[80:83], v[140:143], v[40:43]
    ds_read_b128 v[72:75], v4 offset:4096
    v_mfma_f32_16x16x32_bf16 v[24:27], v[84:87], v[136:139], v[24:27]
    v_mfma_f32_16x16x32_bf16 v[44:47], v[84:87], v[140:143], v[44:47]
    v_mfma_f32_16x16x32_bf16 v[28:31], v[88:91], v[136:139], v[28:31]
    v_mfma_f32_16x16x32_bf16 v[48:51], v[88:91], v[140:143], v[48:51]
    v_mfma_f32_16x16x32_bf16 v[32:35], v[92:95], v[136:139], v[32:35]
    v_mfma_f32_16x16x32_bf16 v[52:55], v[92:95], v[140:143], v[52:55]
    s_barrier
    s_waitcnt vmcnt(4) lgkmcnt(0)
    v_swap_b32 v98, v100
    v_swap_b32 v99, v101
    ds_read_b128 v[76:79], v4 offset:10240
    s_nop 0
    v_mfma_f32_16x16x32_bf16 v[16:19], v[56:59], v[96:99], v[16:19]
    ds_read_b128 v[80:83], v4 offset:11264
    v_mfma_f32_16x16x32_bf16 v[36:39], v[56:59], v[100:103], v[36:39]
    ds_read_b128 v[84:87], v4 offset:12288
    v_mfma_f32_16x16x32_bf16 v[20:23], v[60:63], v[96:99], v[20:23]
    ds_read_b128 v[88:91], v4 offset:13312
    v_mfma_f32_16x16x32_bf16 v[40:43], v[60:63], v[100:103], v[40:43]
    ds_read_b128 v[92:95], v4 offset:14336
    v_mfma_f32_16x16x32_bf16 v[24:27], v[64:67], v[96:99], v[24:27]
    v_mfma_f32_16x16x32_bf16 v[44:47], v[64:67], v[100:103], v[44:47]
    v_mfma_f32_16x16x32_bf16 v[28:31], v[68:71], v[96:99], v[28:31]
    v_mfma_f32_16x16x32_bf16 v[48:51], v[68:71], v[100:103], v[48:51]
    v_mfma_f32_16x16x32_bf16 v[32:35], v[72:75], v[96:99], v[32:35]
    v_mfma_f32_16x16x32_bf16 v[52:55], v[72:75], v[100:103], v[52:55]
    s_add_u32 s27, s27, 20480
    s_sub_u32 s29, s27, 143360
    s_cmp_ge_u32 s27, 143360
    s_cselect_b32 s27, s29, s27
    v_add_u32 v4, s27, v2
    s_waitcnt vmcnt(2) lgkmcnt(0)
    v_swap_b32 v106, v108
    v_swap_b32 v107, v109
    ds_read_b128 v[56:59], v4 offset:0
    s_nop 0
    v_mfma_f32_16x16x32_bf16 v[16:19], v[76:79], v[104:107], v[16:19]
    ds_read_b128 v[60:63], v4 offset:1024
    v_mfma_f32_16x16x32_bf16 v[36:39], v[76:79], v[108:111], v[36:39]
    ds_read_b128 v[64:67], v4 offset:2048
    v_mfma_f32_16x16x32_bf16 v[20:23], v[80:83], v[104:107], v[20:23]
    ds_read_b128 v[68:71], v4 offset:3072
    v_mfma_f32_16x16x32_bf16 v[40:43], v[80:83], v[108:111], v[40:43]
    ds_read_b128 v[72:75], v4 offset:4096
    v_mfma_f32_16x16x32_bf16 v[24:27], v[84:87], v[104:107], v[24:27]
    v_mfma_f32_16x16x32_bf16 v[44:47], v[84:87], v[108:111], v[44:47]
    v_mfma_f32_16x16x32_bf16 v[28:31], v[88:91], v[104:107], v[28:31]
    v_mfma_f32_16x16x32_bf16 v[48:51], v[88:91], v[108:111], v[48:51]
    v_mfma_f32_16x16x32_bf16 v[32:35], v[92:95], v[104:107], v[32:35]
    v_mfma_f32_16x16x32_bf16 v[52:55], v[92:95], v[108:111], v[52:55]
    s_barrier
    s_waitcnt vmcnt(0) lgkmcnt(0)
    v_swap_b32 v114, v116
    v_swap_b32 v115, v117
    s_nop 0
    s_nop 0
    v_mfma_f32_16x16x32_bf16 v[16:19], v[56:59], v[112:115], v[16:19]
    v_mfma_f32_16x16x32_bf16 v[36:39], v[56:59], v[116:119], v[36:39]
    v_mfma_f32_16x16x32_bf16 v[20:23], v[60:63], v[112:115], v[20:23]
    v_mfma_f32_16x16x32_bf16 v[40:43], v[60:63], v[116:119], v[40:43]
    v_mfma_f32_16x16x32_bf16 v[24:27], v[64:67], v[112:115], v[24:27]
    v_mfma_f32_16x16x32_bf16 v[44:47], v[64:67], v[116:119], v[44:47]
    v_mfma_f32_16x16x32_bf16 v[28:31], v[68:71], v[112:115], v[28:31]
    v_mfma_f32_16x16x32_bf16 v[48:51], v[68:71], v[116:119], v[48:51]
    v_mfma_f32_16x16x32_bf16 v[32:35], v[72:75], v[112:115], v[32:35]
    v_mfma_f32_16x16x32_bf16 v[52:55], v[72:75], v[116:119], v[52:55]
    s_barrier
    s_lshr_b32 s29, s24, 1
    s_mul_i32 s30, s24, 5120
    v_lshlrev_b32 v4, 4, v1
    v_add_u32 v5, s30, v4
    s_xor_b32 s33, s24, 2
    s_mul_i32 s33, s33, 5120
    v_add_u32 v4, s33, v4
    s_cmp_eq_u32 s29, 0
    s_cbranch_scc0 L_g2n_send0_f
    ds_write_b128 v5, v[36:39] offset:0
    ds_write_b128 v5, v[40:43] offset:1024
    ds_write_b128 v5, v[44:47] offset:2048
    ds_write_b128 v5, v[48:51] offset:3072
    ds_write_b128 v5, v[52:55] offset:4096
    s_branch L_g2n_sent_f
L_g2n_send0_f:
    ds_write_b128 v5, v[16:19] offset:0
    ds_write_b128 v5, v[20:23] offset:1024
    ds_write_b128 v5, v[24:27] offset:2048
    ds_write_b128 v5, v[28:31] offset:3072
    ds_write_b128 v5, v[32:35] offset:4096
    v_mov_b32 v16, v36
    v_mov_b32 v17, v37
    v_mov_b32 v18, v38
    v_mov_b32 v19, v39
    v_mov_b32 v20, v40
    v_mov_b32 v21, v41
    v_mov_b32 v22, v42
    v_mov_b32 v23, v43
    v_mov_b32 v24, v44
    v_mov_b32 v25, v45
    v_mov_b32 v26, v46
    v_mov_b32 v27, v47
    v_mov_b32 v28, v48
    v_mov_b32 v29, v49
    v_mov_b32 v30, v50
    v_mov_b32 v31, v51
    v_mov_b32 v32, v52
    v_mov_b32 v33, v53
    v_mov_b32 v34, v54
    v_mov_b32 v35, v55
L_g2n_sent_f:
    s_waitcnt lgkmcnt(0)
    s_barrier
    ds_read_b128 v[56:59], v4 offset:0
    ds_read_b128 v[60:63], v4 offset:1024
    ds_read_b128 v[64:67], v4 offset:2048
    ds_read_b128 v[68:71], v4 offset:3072
    ds_read_b128 v[72:75], v4 offset:4096
    v_bfe_u32 v13, v1, 4, 1
    v_lshlrev_b32 v13, 5, v13
    v_bfe_u32 v14, v1, 5, 1
    v_lshl_add_u32 v13, v14, 4, v13
    v_lshrrev_b32 v14, 4, v1
    v_lshlrev_b32 v14, 3, v14
    v_sub_u32 v12, v11, v14
    v_add_u32 v12, v12, v13
    s_waitcnt vmcnt(0)
    s_waitcnt lgkmcnt(4)
    v_pk_add_f32 v[16:17], v[16:17], v[56:57]
    v_pk_add_f32 v[18:19], v[18:19], v[58:59]
    v_cvt_pk_bf16_f32 v210, v16, v17
    v_cvt_pk_bf16_f32 v211, v18, v19
    v_lshlrev_b32 v56, 16, v200
    v_and_b32 v57, 0xffff0000, v200
    v_lshlrev_b32 v58, 16, v201
    v_and_b32 v59, 0xffff0000, v201
    v_lshlrev_b32 v16, 16, v210
    v_and_b32 v17, 0xffff0000, v210
    v_lshlrev_b32 v18, 16, v211
    v_and_b32 v19, 0xffff0000, v211
    v_pk_add_f32 v[16:17], v[16:17], v[56:57]
    v_pk_add_f32 v[18:19], v[18:19], v[58:59]
    v_cvt_pk_bf16_f32 v200, v16, v17
    v_cvt_pk_bf16_f32 v201, v18, v19
    s_waitcnt lgkmcnt(3)
    v_pk_add_f32 v[20:21], v[20:21], v[60:61]
    v_pk_add_f32 v[22:23], v[22:23], v[62:63]
    v_cvt_pk_bf16_f32 v210, v20, v21
    v_cvt_pk_bf16_f32 v211, v22, v23
    v_lshlrev_b32 v60, 16, v202
    v_and_b32 v61, 0xffff0000, v202
    v_lshlrev_b32 v62, 16, v203
    v_and_b32 v63, 0xffff0000, v203
    v_lshlrev_b32 v20, 16, v210
    v_and_b32 v21, 0xffff0000, v210
    v_lshlrev_b32 v22, 16, v211
    v_and_b32 v23, 0xffff0000, v211
    v_pk_add_f32 v[20:21], v[20:21], v[60:61]
    v_pk_add_f32 v[22:23], v[22:23], v[62:63]
    v_cvt_pk_bf16_f32 v202, v20, v21
    v_cvt_pk_bf16_f32 v203, v22, v23
    s_nop 0
    v_permlane16_swap_b32 v200, v202
    v_permlane16_swap_b32 v201, v203
    buffer_store_dwordx4 v[200:203], v12, s[20:23], 0 offen offset:0
    s_waitcnt lgkmcnt(2)
    v_pk_add_f32 v[24:25], v[24:25], v[64:65]
    v_pk_add_f32 v[26:27], v[26:27], v[66:67]
    v_cvt_pk_bf16_f32 v210, v24, v25
    v_cvt_pk_bf16_f32 v211, v26, v27
    v_lshlrev_b32 v64, 16, v204
    v_and_b32 v65, 0xffff0000, v204
    v_lshlrev_b32 v66, 16, v205
    v_and_b32 v67, 0xffff0000, v205
    v_lshlrev_b32 v24, 16, v210
    v_and_b32 v25, 0xffff0000, v210
    v_lshlrev_b32 v26, 16, v211
    v_and_b32 v27, 0xffff0000, v211
    v_pk_add_f32 v[24:25], v[24:25], v[64:65]
    v_pk_add_f32 v[26:27], v[26:27], v[66:67]
    v_cvt_pk_bf16_f32 v204, v24, v25
    v_cvt_pk_bf16_f32 v205, v26, v27
    s_waitcnt lgkmcnt(1)
    v_pk_add_f32 v[28:29], v[28:29], v[68:69]
    v_pk_add_f32 v[30:31], v[30:31], v[70:71]
    v_cvt_pk_bf16_f32 v210, v28, v29
    v_cvt_pk_bf16_f32 v211, v30, v31
    v_lshlrev_b32 v68, 16, v206
    v_and_b32 v69, 0xffff0000, v206
    v_lshlrev_b32 v70, 16, v207
    v_and_b32 v71, 0xffff0000, v207
    v_lshlrev_b32 v28, 16, v210
    v_and_b32 v29, 0xffff0000, v210
    v_lshlrev_b32 v30, 16, v211
    v_and_b32 v31, 0xffff0000, v211
    v_pk_add_f32 v[28:29], v[28:29], v[68:69]
    v_pk_add_f32 v[30:31], v[30:31], v[70:71]
    v_cvt_pk_bf16_f32 v206, v28, v29
    v_cvt_pk_bf16_f32 v207, v30, v31
    s_nop 0
    v_permlane16_swap_b32 v204, v206
    v_permlane16_swap_b32 v205, v207
    buffer_store_dwordx4 v[204:207], v12, s[20:23], 0 offen offset:64
    s_waitcnt lgkmcnt(0)
    v_pk_add_f32 v[32:33], v[32:33], v[72:73]
    v_pk_add_f32 v[34:35], v[34:35], v[74:75]
    v_cvt_pk_bf16_f32 v210, v32, v33
    v_cvt_pk_bf16_f32 v211, v34, v35
    v_lshlrev_b32 v72, 16, v208
    v_and_b32 v73, 0xffff0000, v208
    v_lshlrev_b32 v74, 16, v209
    v_and_b32 v75, 0xffff0000, v209
    v_lshlrev_b32 v32, 16, v210
    v_and_b32 v33, 0xffff0000, v210
    v_lshlrev_b32 v34, 16, v211
    v_and_b32 v35, 0xffff0000, v211
    v_pk_add_f32 v[32:33], v[32:33], v[72:73]
    v_pk_add_f32 v[34:35], v[34:35], v[74:75]
    v_cvt_pk_bf16_f32 v208, v32, v33
    v_cvt_pk_bf16_f32 v209, v34, v35
    buffer_store_dwordx2 v[208:209], v11, s[20:23], 0 offen offset:128
    s_branch L_ffn_fin_f
L_ffn_loader_f:
    v_lshlrev_b32 v4, 4, v1
    s_lshl_b32 s30, s25, 10
    v_add_u32 v2, s30, v4
    s_lshl_b32 s30, s27, 11
    v_add_u32 v3, s30, v4
    s_lshl_b32 s30, s27, 6
    v_add_u32 v5, s30, v4
    s_sub_u32 s29, s24, 4
    s_lshr_b32 s31, s29, 1
    s_mul_i32 s33, s31, 131072
    s_mul_i32 s34, s31, 221184
    s_mul_i32 s32, s31, 23552
    s_and_b32 s29, s29, 1
    s_cmp_eq_u32 s29, 0
    s_cbranch_scc0 L_g1_h1_f
    s_and_b32 s84, s2, 3
    s_lshl_b32 s84, s84, 7
    s_add_u32 s84, s84, 7424
    v_mov_b32 v7, s84
    s_mov_b32 s85, 0
    s_mov_b64 exec, 1
L_rpw1_poll:
    buffer_load_dword v8, v7, s[88:91], 0 offen sc1
    s_waitcnt vmcnt(0)
    v_readfirstlane_b32 s94, v8
    s_nop 0
    s_cmp_lg_u32 s94, 0
    s_cbranch_scc1 L_rpw1_ok
    s_add_u32 s85, s85, 1
    s_cmp_lt_u32 s85, 200000
    s_cbranch_scc1 L_rpw1_poll
L_rpw1_ok:
    s_mov_b64 exec, -1
    s_mov_b32 s46, s32
    s_mov_b32 s47, s33
    s_add_u32 m0, s32, 0
    s_add_u32 s30, s34, 0
    buffer_load_dwordx4 v3, s[12:15], s30 offen  lds
    s_add_u32 m0, s32, 1024
    s_add_u32 s30, s34, 1024
    buffer_load_dwordx4 v3, s[12:15], s30 offen  lds
    s_add_u32 m0, s32, 2048
    s_add_u32 s30, s34, 2048
    buffer_load_dwordx4 v3, s[12:15], s30 offen  lds
    s_add_u32 s33, s33, 262144
    s_add_u32 s34, s34, 442368
    s_add_u32 s32, s32, 47104
    s_sub_u32 s31, s32, 141312
    s_cmp_ge_u32 s32, 141312
    s_cselect_b32 s32, s31, s32
    s_add_u32 m0, s32, 0
    s_add_u32 s30, s34, 0
    buffer_load_dwordx4 v3, s[12:15], s30 offen  lds
    s_add_u32 m0, s32, 1024
    s_add_u32 s30, s34, 1024
    buffer_load_dwordx4 v3, s[12:15], s30 offen  lds
    s_add_u32 m0, s32, 2048
    s_add_u32 s30, s34, 2048
    buffer_load_dwordx4 v3, s[12:15], s30 offen  lds
    s_add_u32 s33, s33, 262144
    s_add_u32 s34, s34, 442368
    s_add_u32 s32, s32, 47104
    s_sub_u32 s31, s32, 141312
    s_cmp_ge_u32 s32, 141312
    s_cselect_b32 s32, s31, s32
    s_add_u32 m0, s32, 0
    s_add_u32 s30, s34, 0
    buffer_load_dwordx4 v3, s[12:15], s30 offen  lds
    s_add_u32 m0, s32, 1024
    s_add_u32 s30, s34, 1024
    buffer_load_dwordx4 v3, s[12:15], s30 offen  lds
    s_add_u32 m0, s32, 2048
    s_add_u32 s30, s34, 2048
    buffer_load_dwordx4 v3, s[12:15], s30 offen  lds
    s_add_u32 s33, s33, 262144
    s_add_u32 s34, s34, 442368
    s_add_u32 s32, s32, 47104
    s_sub_u32 s31, s32, 141312
    s_cmp_ge_u32 s32, 141312
    s_cselect_b32 s32, s31, s32
    s_mov_b32 s48, s32
    s_mov_b32 s49, s33
    s_mov_b32 s32, s46
    s_mov_b32 s33, s47
    s_mov_b32 s50, s34
    s_barrier
    s_lshl_b32 s30, s25, 7
    s_lshl_b32 s31, s26, 3
    s_add_u32 s30, s30, s31
    s_sub_u32 s31, s24, 4
    s_lshl_b32 s31, s31, 1
    s_add_u32 s30, s30, s31
    s_lshl_b32 s94, s30, 3
    v_lshlrev_b32 v196, 14, v1
    v_add_u32 v196, s94, v196
    buffer_load_dwordx4 v[200:203], v196, s[8:11], 0 offen
    s_mov_b32 s31, 1048576
    buffer_load_dwordx4 v[204:207], v196, s[8:11], s31 offen
    s_mov_b32 s31, 2097152
    buffer_load_dwordx4 v[208:211], v196, s[8:11], s31 offen
    s_add_u32 m0, s32, 14336
    s_add_u32 s30, s33, 0
    buffer_load_dwordx4 v2, s[8:11], s30 offen  lds
    s_add_u32 m0, s32, 15488
    s_add_u32 s30, s33, 16384
    buffer_load_dwordx4 v2, s[8:11], s30 offen  lds
    s_add_u32 m0, s32, 16640
    s_add_u32 s30, s33, 32768
    buffer_load_dwordx4 v2, s[8:11], s30 offen  lds
    s_add_u32 m0, s32, 17792
    s_add_u32 s30, s33, 49152
    buffer_load_dwordx4 v2, s[8:11], s30 offen  lds
    s_add_u32 m0, s32, 18944
    s_add_u32 s30, s33, 65536
    buffer_load_dwordx4 v2, s[8:11], s30 offen  lds
    s_add_u32 m0, s32, 20096
    s_add_u32 s30, s33, 81920
    buffer_load_dwordx4 v2, s[8:11], s30 offen  lds
    s_add_u32 m0, s32, 21248
    s_add_u32 s30, s33, 98304
    buffer_load_dwordx4 v2, s[8:11], s30 offen  lds
    s_add_u32 m0, s32, 22400
    s_add_u32 s30, s33, 114688
    buffer_load_dwordx4 v2, s[8:11], s30 offen  lds
    s_add_u32 s33, s33, 262144
    s_add_u32 s34, s34, 442368
    s_add_u32 s32, s32, 47104
    s_sub_u32 s31, s32, 141312
    s_cmp_ge_u32 s32, 141312
    s_cselect_b32 s32, s31, s32
    s_add_u32 m0, s32, 14336
    s_add_u32 s30, s33, 0
    buffer_load_dwordx4 v2, s[8:11], s30 offen  lds
    s_add_u32 m0, s32, 15488
    s_add_u32 s30, s33, 16384
    buffer_load_dwordx4 v2, s[8:11], s30 offen  lds
    s_add_u32 m0, s32, 16640
    s_add_u32 s30, s33, 32768
    buffer_load_dwordx4 v2, s[8:11], s30 offen  lds
    s_add_u32 m0, s32, 17792
    s_add_u32 s30, s33, 49152
    buffer_load_dwordx4 v2, s[8:11], s30 offen  lds
    s_add_u32 m0, s32, 18944
    s_add_u32 s30, s33, 65536
    buffer_load_dwordx4 v2, s[8:11], s30 offen  lds
    s_add_u32 m0, s32, 20096
    s_add_u32 s30, s33, 81920
    buffer_load_dwordx4 v2, s[8:11], s30 offen  lds
    s_add_u32 m0, s32, 21248
    s_add_u32 s30, s33, 98304
    buffer_load_dwordx4 v2, s[8:11], s30 offen  lds
    s_add_u32 m0, s32, 22400
    s_add_u32 s30, s33, 114688
    buffer_load_dwordx4 v2, s[8:11], s30 offen  lds
    s_add_u32 s33, s33, 262144
    s_add_u32 s34, s34, 442368
    s_add_u32 s32, s32, 47104
    s_sub_u32 s31, s32, 141312
    s_cmp_ge_u32 s32, 141312
    s_cselect_b32 s32, s31, s32
    s_add_u32 m0, s32, 14336
    s_add_u32 s30, s33, 0
    buffer_load_dwordx4 v2, s[8:11], s30 offen  lds
    s_add_u32 m0, s32, 15488
    s_add_u32 s30, s33, 16384
    buffer_load_dwordx4 v2, s[8:11], s30 offen  lds
    s_add_u32 m0, s32, 16640
    s_add_u32 s30, s33, 32768
    buffer_load_dwordx4 v2, s[8:11], s30 offen  lds
    s_add_u32 m0, s32, 17792
    s_add_u32 s30, s33, 49152
    buffer_load_dwordx4 v2, s[8:11], s30 offen  lds
    s_add_u32 m0, s32, 18944
    s_add_u32 s30, s33, 65536
    buffer_load_dwordx4 v2, s[8:11], s30 offen  lds
    s_add_u32 m0, s32, 20096
    s_add_u32 s30, s33, 81920
    buffer_load_dwordx4 v2, s[8:11], s30 offen  lds
    s_add_u32 m0, s32, 21248
    s_add_u32 s30, s33, 98304
    buffer_load_dwordx4 v2, s[8:11], s30 offen  lds
    s_add_u32 m0, s32, 22400
    s_add_u32 s30, s33, 114688
    buffer_load_dwordx4 v2, s[8:11], s30 offen  lds
    s_add_u32 s33, s33, 262144
    s_add_u32 s34, s34, 442368
    s_add_u32 s32, s32, 47104
    s_sub_u32 s31, s32, 141312
    s_cmp_ge_u32 s32, 141312
    s_cselect_b32 s32, s31, s32
    s_mov_b32 s32, s48
    s_mov_b32 s33, s49
    s_mov_b32 s34, s50
    s_waitcnt vmcnt(16)
    s_barrier
    s_mov_b32 s30, 0
    buffer_load_dwordx4 v[16:19], v5, s[20:23], s30 offen
    s_mov_b32 s30, 13824
    buffer_load_dwordx4 v[20:23], v5, s[20:23], s30 offen
    s_mov_b32 s30, 27648
    buffer_load_dwordx4 v[24:27], v5, s[20:23], s30 offen
    s_mov_b32 s30, 41472
    buffer_load_dwordx4 v[28:31], v5, s[20:23], s30 offen
    s_mov_b32 s30, 6912
    buffer_load_dwordx4 v[32:35], v5, s[20:23], s30 offen
    s_mov_b32 s30, 20736
    buffer_load_dwordx4 v[36:39], v5, s[20:23], s30 offen
    s_mov_b32 s30, 34560
    buffer_load_dwordx4 v[40:43], v5, s[20:23], s30 offen
    s_mov_b32 s30, 48384
    buffer_load_dwordx4 v[44:47], v5, s[20:23], s30 offen
    s_waitcnt vmcnt(16)
    s_barrier
    s_add_u32 m0, s32, 14336
    s_add_u32 s30, s33, 0
    buffer_load_dwordx4 v2, s[8:11], s30 offen  lds
    s_add_u32 m0, s32, 15488
    s_add_u32 s30, s33, 16384
    buffer_load_dwordx4 v2, s[8:11], s30 offen  lds
    s_add_u32 m0, s32, 16640
    s_add_u32 s30, s33, 32768
    buffer_load_dwordx4 v2, s[8:11], s30 offen  lds
    s_add_u32 m0, s32, 17792
    s_add_u32 s30, s33, 49152
    buffer_load_dwordx4 v2, s[8:11], s30 offen  lds
    s_add_u32 m0, s32, 18944
    s_add_u32 s30, s33, 65536
    buffer_load_dwordx4 v2, s[8:11], s30 offen  lds
    s_add_u32 m0, s32, 20096
    s_add_u32 s30, s33, 81920
    buffer_load_dwordx4 v2, s[8:11], s30 offen  lds
    s_add_u32 m0, s32, 21248
    s_add_u32 s30, s33, 98304
    buffer_load_dwordx4 v2, s[8:11], s30 offen  lds
    s_add_u32 m0, s32, 22400
    s_add_u32 s30, s33, 114688
    buffer_load_dwordx4 v2, s[8:11], s30 offen  lds
    s_add_u32 m0, s32, 0
    s_add_u32 s30, s34, 0
    buffer_load_dwordx4 v3, s[12:15], s30 offen  lds
    s_add_u32 m0, s32, 1024
    s_add_u32 s30, s34, 1024
    buffer_load_dwordx4 v3, s[12:15], s30 offen  lds
    s_add_u32 m0, s32, 2048
    s_add_u32 s30, s34, 2048
    buffer_load_dwordx4 v3, s[12:15], s30 offen  lds
    s_add_u32 s33, s33, 262144
    s_add_u32 s34, s34, 442368
    s_add_u32 s32, s32, 47104
    s_sub_u32 s31, s32, 141312
    s_cmp_ge_u32 s32, 141312
    s_cselect_b32 s32, s31, s32
    s_waitcnt vmcnt(11)
    v_mov_b32 v198, 0x3f803f80
    v_mov_b32 v192, 0
    v_mov_b32 v193, 0
    v_mov_b32 v194, 0
    v_mov_b32 v195, 0
    v_dot2_f32_bf16 v192, v200, v198, v192
    v_dot2_f32_bf16 v193, v202, v198, v193
    v_dot2_f32_bf16 v194, v200, v200, v194
    v_dot2_f32_bf16 v195, v202, v202, v195
    v_dot2_f32_bf16 v192, v201, v198, v192
    v_dot2_f32_bf16 v193, v203, v198, v193
    v_dot2_f32_bf16 v194, v201, v201, v194
    v_dot2_f32_bf16 v195, v203, v203, v195
    v_dot2_f32_bf16 v192, v204, v198, v192
    v_dot2_f32_bf16 v193, v206, v198, v193
    v_dot2_f32_bf16 v194, v204, v204, v194
    v_dot2_f32_bf16 v195, v206, v206, v195
    v_dot2_f32_bf16 v192, v205, v198, v192
    v_dot2_f32_bf16 v193, v207, v198, v193
    v_dot2_f32_bf16 v194, v205, v205, v194
    v_dot2_f32_bf16 v195, v207, v207, v195
    v_dot2_f32_bf16 v192, v208, v198, v192
    v_dot2_f32_bf16 v193, v210, v198, v193
    v_dot2_f32_bf16 v194, v208, v208, v194
    v_dot2_f32_bf16 v195, v210, v210, v195
    v_dot2_f32_bf16 v192, v209, v198, v192
    v_dot2_f32_bf16 v193, v211, v198, v193
    v_dot2_f32_bf16 v194, v209, v209, v194
    v_dot2_f32_bf16 v195, v211, v211, v195
    v_add_f32_dpp v192, v192, v192 row_ror:1 row_mask:0xf bank_mask:0xf
    s_nop 1
    v_add_f32_dpp v192, v192, v192 row_ror:2 row_mask:0xf bank_mask:0xf
    s_nop 1
    v_add_f32_dpp v192, v192, v192 row_ror:4 row_mask:0xf bank_mask:0xf
    s_nop 1
    v_add_f32_dpp v192, v192, v192 row_ror:8 row_mask:0xf bank_mask:0xf
    v_mov_b32 v197, v192
    s_nop 1
    v_permlane16_swap_b32 v192, v197
    v_add_f32 v192, v192, v197
    v_mov_b32 v197, v192
    s_nop 1
    v_permlane32_swap_b32 v192, v197
    v_add_f32 v192, v192, v197
    v_add_f32_dpp v193, v193, v193 row_ror:1 row_mask:0xf bank_mask:0xf
    s_nop 1
    v_add_f32_dpp v193, v193, v193 row_ror:2 row_mask:0xf bank_mask:0xf
    s_nop 1
    v_add_f32_dpp v193, v193, v193 row_ror:4 row_mask:0xf bank_mask:0xf
    s_nop 1
    v_add_f32_dpp v193, v193, v193 row_ror:8 row_mask:0xf bank_mask:0xf
    v_mov_b32 v197, v193
    s_nop 1
    v_permlane16_swap_b32 v193, v197
    v_add_f32 v193, v193, v197
    v_mov_b32 v197, v193
    s_nop 1
    v_permlane32_swap_b32 v193, v197
    v_add_f32 v193, v193, v197
    v_add_f32_dpp v194, v194, v194 row_ror:1 row_mask:0xf bank_mask:0xf
    s_nop 1
    v_add_f32_dpp v194, v194, v194 row_ror:2 row_mask:0xf bank_mask:0xf
    s_nop 1
    v_add_f32_dpp v194, v194, v194 row_ror:4 row_mask:0xf bank_mask:0xf
    s_nop 1
    v_add_f32_dpp v194, v194, v194 row_ror:8 row_mask:0xf bank_mask:0xf
    v_mov_b32 v197, v194
    s_nop 1
    v_permlane16_swap_b32 v194, v197
    v_add_f32 v194, v194, v197
    v_mov_b32 v197, v194
    s_nop 1
    v_permlane32_swap_b32 v194, v197
    v_add_f32 v194, v194, v197
    v_add_f32_dpp v195, v195, v195 row_ror:1 row_mask:0xf bank_mask:0xf
    s_nop 1
    v_add_f32_dpp v195, v195, v195 row_ror:2 row_mask:0xf bank_mask:0xf
    s_nop 1
    v_add_f32_dpp v195, v195, v195 row_ror:4 row_mask:0xf bank_mask:0xf
    s_nop 1
    v_add_f32_dpp v195, v195, v195 row_ror:8 row_mask:0xf bank_mask:0xf
    v_mov_b32 v197, v195
    s_nop 1
    v_permlane16_swap_b32 v195, v197
    v_add_f32 v195, v195, v197
    v_mov_b32 v197, v195
    s_nop 1
    v_permlane32_swap_b32 v195, v197
    v_add_f32 v195, v195, v197
    v_mul_f32 v192, 0x3acccccd, v192
    v_mul_f32 v193, 0x3acccccd, v193
    v_mul_f32 v194, 0x3acccccd, v194
    v_mul_f32 v195, 0x3acccccd, v195
    v_fma_f32 v194, -v192, v192, v194
    v_fma_f32 v195, -v193, v193, v195
    v_max_f32 v194, 0, v194
    v_max_f32 v195, 0, v195
    v_cvt_pk_bf16_f32 v192, v192, v192
    v_lshlrev_b32 v192, 16, v192
    v_cvt_pk_bf16_f32 v194, v194, v194
    v_lshlrev_b32 v194, 16, v194
    v_add_f32 v194, 0x3727c5ac, v194
    v_cvt_pk_bf16_f32 v194, v194, v194
    v_lshlrev_b32 v194, 16, v194
    v_sqrt_f32 v194, v194
    s_nop 0
    v_cvt_pk_bf16_f32 v194, v194, v194
    v_lshlrev_b32 v194, 16, v194
    v_rcp_f32 v194, v194
    v_cvt_pk_bf16_f32 v193, v193, v193
    v_lshlrev_b32 v193, 16, v193
    v_cvt_pk_bf16_f32 v195, v195, v195
    v_lshlrev_b32 v195, 16, v195
    v_add_f32 v195, 0x3727c5ac, v195
    v_cvt_pk_bf16_f32 v195, v195, v195
    v_lshlrev_b32 v195, 16, v195
    v_sqrt_f32 v195, v195
    s_nop 0
    v_cvt_pk_bf16_f32 v195, v195, v195
    v_lshlrev_b32 v195, 16, v195
    v_rcp_f32 v195, v195
    v_mov_b32 v212, v192
    v_mov_b32 v213, v194
    v_mov_b32 v214, v193
    v_mov_b32 v215, v195
    v_mov_b32 v196, s94
    s_mov_b64 exec, 1
    buffer_store_dwordx4 v[212:215], v196, s[36:39], 0 offen sc1
    s_mov_b64 exec, -1
    v_add_f32 v16, v16, v20
    v_add_f32 v24, v24, v28
    v_add_f32 v16, v16, v24
    v_add_f32 v17, v17, v21
    v_add_f32 v25, v25, v29
    v_add_f32 v17, v17, v25
    v_add_f32 v18, v18, v22
    v_add_f32 v26, v26, v30
    v_add_f32 v18, v18, v26
    v_add_f32 v19, v19, v23
    v_add_f32 v27, v27, v31
    v_add_f32 v19, v19, v27
    v_add_f32 v32, v32, v36
    v_add_f32 v40, v40, v44
    v_add_f32 v32, v32, v40
    v_add_f32 v33, v33, v37
    v_add_f32 v41, v41, v45
    v_add_f32 v33, v33, v41
    v_add_f32 v34, v34, v38
    v_add_f32 v42, v42, v46
    v_add_f32 v34, v34, v42
    v_add_f32 v35, v35, v39
    v_add_f32 v43, v43, v47
    v_add_f32 v35, v35, v43
    v_lshlrev_b32 v6, 4, v1
    v_add_u32 v6, 143360, v6
    s_mov_b64 exec, 0xfffffff
    ds_write_b128 v6, v[16:19]
    ds_write_b128 v6, v[32:35] offset:448
    s_mov_b64 exec, -1
    s_mov_b32 s29, 2
L_g1_ld0_f:
    s_waitcnt vmcnt(11) lgkmcnt(0)
    s_barrier
    s_add_u32 m0, s32, 14336
    s_add_u32 s30, s33, 0
    buffer_load_dwordx4 v2, s[8:11], s30 offen  lds
    s_add_u32 m0, s32, 15488
    s_add_u32 s30, s33, 16384
    buffer_load_dwordx4 v2, s[8:11], s30 offen  lds
    s_add_u32 m0, s32, 16640
    s_add_u32 s30, s33, 32768
    buffer_load_dwordx4 v2, s[8:11], s30 offen  lds
    s_add_u32 m0, s32, 17792
    s_add_u32 s30, s33, 49152
    buffer_load_dwordx4 v2, s[8:11], s30 offen  lds
    s_add_u32 m0, s32, 18944
    s_add_u32 s30, s33, 65536
    buffer_load_dwordx4 v2, s[8:11], s30 offen  lds
    s_add_u32 m0, s32, 20096
    s_add_u32 s30, s33, 81920
    buffer_load_dwordx4 v2, s[8:11], s30 offen  lds
    s_add_u32 m0, s32, 21248
    s_add_u32 s30, s33, 98304
    buffer_load_dwordx4 v2, s[8:11], s30 offen  lds
    s_add_u32 m0, s32, 22400
    s_add_u32 s30, s33, 114688
    buffer_load_dwordx4 v2, s[8:11], s30 offen  lds
    s_add_u32 m0, s32, 0
    s_add_u32 s30, s34, 0
    buffer_load_dwordx4 v3, s[12:15], s30 offen  lds
    s_add_u32 m0, s32, 1024
    s_add_u32 s30, s34, 1024
    buffer_load_dwordx4 v3, s[12:15], s30 offen  lds
    s_add_u32 m0, s32, 2048
    s_add_u32 s30, s34, 2048
    buffer_load_dwordx4 v3, s[12:15], s30 offen  lds
    s_add_u32 s33, s33, 262144
    s_add_u32 s34, s34, 442368
    s_add_u32 s32, s32, 47104
    s_sub_u32 s31, s32, 141312
    s_cmp_ge_u32 s32, 141312
    s_cselect_b32 s32, s31, s32
    s_add_u32 s29, s29, 1
    s_cmp_lt_u32 s29, 8
    s_cbranch_scc1 L_g1_ld0_f
    s_waitcnt vmcnt(11)
    s_barrier
    s_waitcnt vmcnt(0)
    s_barrier
    s_branch L_g1_ldone_f
L_g1_h1_f:
    s_and_b32 s84, s2, 3
    s_lshl_b32 s84, s84, 7
    s_add_u32 s84, s84, 7424
    v_mov_b32 v7, s84
    s_mov_b32 s85, 0
    s_mov_b64 exec, 1
L_rpw2_poll:
    buffer_load_dword v8, v7, s[88:91], 0 offen sc1
    s_waitcnt vmcnt(0)
    v_readfirstlane_b32 s94, v8
    s_nop 0
    s_cmp_lg_u32 s94, 0
    s_cbranch_scc1 L_rpw2_ok
    s_add_u32 s85, s85, 1
    s_cmp_lt_u32 s85, 200000
    s_cbranch_scc1 L_rpw2_poll
L_rpw2_ok:
    s_mov_b64 exec, -1
    s_mov_b32 s46, s32
    s_mov_b32 s47, s33
    s_add_u32 m0, s32, 3072
    s_add_u32 s30, s34, 3072
    buffer_load_dwordx4 v3, s[12:15], s30 offen  lds
    s_add_u32 m0, s32, 4096
    s_add_u32 s30, s34, 4096
    buffer_load_dwordx4 v3, s[12:15], s30 offen  lds
    s_add_u32 m0, s32, 5120
    s_add_u32 s30, s34, 5120
    buffer_load_dwordx4 v3, s[12:15], s30 offen  lds
    s_add_u32 m0, s32, 6144
    s_add_u32 s30, s34, 6144
    buffer_load_dwordx4 v3, s[12:15], s30 offen  lds
    s_add_u32 m0, s32, 7168
    s_add_u32 s30, s34, 7168
    buffer_load_dwordx4 v3, s[12:15], s30 offen  lds
    s_add_u32 m0, s32, 8192
    s_add_u32 s30, s34, 8192
    buffer_load_dwordx4 v3, s[12:15], s30 offen  lds
    s_add_u32 m0, s32, 9216
    s_add_u32 s30, s34, 9216
    buffer_load_dwordx4 v3, s[12:15], s30 offen  lds
    s_add_u32 m0, s32, 10240
    s_add_u32 s30, s34, 10240
    buffer_load_dwordx4 v3, s[12:15], s30 offen  lds
    s_add_u32 m0, s32, 11264
    s_add_u32 s30, s34, 11264
    buffer_load_dwordx4 v3, s[12:15], s30 offen  lds
    s_add_u32 m0, s32, 12288
    s_add_u32 s30, s34, 12288
    buffer_load_dwordx4 v3, s[12:15], s30 offen  lds
    s_add_u32 m0, s32, 13312
    s_add_u32 s30, s34, 13312
    buffer_load_dwordx4 v3, s[12:15], s30 offen  lds
    s_add_u32 s33, s33, 262144
    s_add_u32 s34, s34, 442368
    s_add_u32 s32, s32, 47104
    s_sub_u32 s31, s32, 141312
    s_cmp_ge_u32 s32, 141312
    s_cselect_b32 s32, s31, s32
    s_add_u32 m0, s32, 3072
    s_add_u32 s30, s34, 3072
    buffer_load_dwordx4 v3, s[12:15], s30 offen  lds
    s_add_u32 m0, s32, 4096
    s_add_u32 s30, s34, 4096
    buffer_load_dwordx4 v3, s[12:15], s30 offen  lds
    s_add_u32 m0, s32, 5120
    s_add_u32 s30, s34, 5120
    buffer_load_dwordx4 v3, s[12:15], s30 offen  lds
    s_add_u32 m0, s32, 6144
    s_add_u32 s30, s34, 6144
    buffer_load_dwordx4 v3, s[12:15], s30 offen  lds
    s_add_u32 m0, s32, 7168
    s_add_u32 s30, s34, 7168
    buffer_load_dwordx4 v3, s[12:15], s30 offen  lds
    s_add_u32 m0, s32, 8192
    s_add_u32 s30, s34, 8192
    buffer_load_dwordx4 v3, s[12:15], s30 offen  lds
    s_add_u32 m0, s32, 9216
    s_add_u32 s30, s34, 9216
    buffer_load_dwordx4 v3, s[12:15], s30 offen  lds
    s_add_u32 m0, s32, 10240
    s_add_u32 s30, s34, 10240
    buffer_load_dwordx4 v3, s[12:15], s30 offen  lds
    s_add_u32 m0, s32, 11264
    s_add_u32 s30, s34, 11264
    buffer_load_dwordx4 v3, s[12:15], s30 offen  lds
    s_add_u32 m0, s32, 12288
    s_add_u32 s30, s34, 12288
    buffer_load_dwordx4 v3, s[12:15], s30 offen  lds
    s_add_u32 m0, s32, 13312
    s_add_u32 s30, s34, 13312
    buffer_load_dwordx4 v3, s[12:15], s30 offen  lds
    s_add_u32 s33, s33, 262144
    s_add_u32 s34, s34, 442368
    s_add_u32 s32, s32, 47104
    s_sub_u32 s31, s32, 141312
    s_cmp_ge_u32 s32, 141312
    s_cselect_b32 s32, s31, s32
    s_add_u32 m0, s32, 3072
    s_add_u32 s30, s34, 3072
    buffer_load_dwordx4 v3, s[12:15], s30 offen  lds
    s_add_u32 m0, s32, 4096
    s_add_u32 s30, s34, 4096
    buffer_load_dwordx4 v3, s[12:15], s30 offen  lds
    s_add_u32 m0, s32, 5120
    s_add_u32 s30, s34, 5120
    buffer_load_dwordx4 v3, s[12:15], s30 offen  lds
    s_add_u32 m0, s32, 6144
    s_add_u32 s30, s34, 6144
    buffer_load_dwordx4 v3, s[12:15], s30 offen  lds
    s_add_u32 m0, s32, 7168
    s_add_u32 s30, s34, 7168
    buffer_load_dwordx4 v3, s[12:15], s30 offen  lds
    s_add_u32 m0, s32, 8192
    s_add_u32 s30, s34, 8192
    buffer_load_dwordx4 v3, s[12:15], s30 offen  lds
    s_add_u32 m0, s32, 9216
    s_add_u32 s30, s34, 9216
    buffer_load_dwordx4 v3, s[12:15], s30 offen  lds
    s_add_u32 m0, s32, 10240
    s_add_u32 s30, s34, 10240
    buffer_load_dwordx4 v3, s[12:15], s30 offen  lds
    s_add_u32 m0, s32, 11264
    s_add_u32 s30, s34, 11264
    buffer_load_dwordx4 v3, s[12:15], s30 offen  lds
    s_add_u32 m0, s32, 12288
    s_add_u32 s30, s34, 12288
    buffer_load_dwordx4 v3, s[12:15], s30 offen  lds
    s_add_u32 m0, s32, 13312
    s_add_u32 s30, s34, 13312
    buffer_load_dwordx4 v3, s[12:15], s30 offen  lds
    s_add_u32 s33, s33, 262144
    s_add_u32 s34, s34, 442368
    s_add_u32 s32, s32, 47104
    s_sub_u32 s31, s32, 141312
    s_cmp_ge_u32 s32, 141312
    s_cselect_b32 s32, s31, s32
    s_mov_b32 s48, s32
    s_mov_b32 s49, s33
    s_mov_b32 s32, s46
    s_mov_b32 s33, s47
    s_mov_b32 s50, s34
    s_barrier
    s_lshl_b32 s30, s25, 7
    s_lshl_b32 s31, s26, 3
    s_add_u32 s30, s30, s31
    s_sub_u32 s31, s24, 4
    s_lshl_b32 s31, s31, 1
    s_add_u32 s30, s30, s31
    s_lshl_b32 s94, s30, 3
    v_lshlrev_b32 v196, 14, v1
    v_add_u32 v196, s94, v196
    buffer_load_dwordx4 v[200:203], v196, s[8:11], 0 offen
    s_mov_b32 s31, 1048576
    buffer_load_dwordx4 v[204:207], v196, s[8:11], s31 offen
    s_mov_b32 s31, 2097152
    buffer_load_dwordx4 v[208:211], v196, s[8:11], s31 offen
    s_add_u32 s33, s33, 262144
    s_add_u32 s34, s34, 442368
    s_add_u32 s32, s32, 47104
    s_sub_u32 s31, s32, 141312
    s_cmp_ge_u32 s32, 141312
    s_cselect_b32 s32, s31, s32
    s_add_u32 s33, s33, 262144
    s_add_u32 s34, s34, 442368
    s_add_u32 s32, s32, 47104
    s_sub_u32 s31, s32, 141312
    s_cmp_ge_u32 s32, 141312
    s_cselect_b32 s32, s31, s32
    s_add_u32 s33, s33, 262144
    s_add_u32 s34, s34, 442368
    s_add_u32 s32, s32, 47104
    s_sub_u32 s31, s32, 141312
    s_cmp_ge_u32 s32, 141312
    s_cselect_b32 s32, s31, s32
    s_mov_b32 s32, s48
    s_mov_b32 s33, s49
    s_mov_b32 s34, s50
    s_waitcnt vmcnt(25)
    s_barrier
    s_mov_b32 s30, 0
    buffer_load_dwordx4 v[16:19], v5, s[20:23], s30 offen
    s_mov_b32 s30, 13824
    buffer_load_dwordx4 v[20:23], v5, s[20:23], s30 offen
    s_mov_b32 s30, 27648
    buffer_load_dwordx4 v[24:27], v5, s[20:23], s30 offen
    s_mov_b32 s30, 41472
    buffer_load_dwordx4 v[28:31], v5, s[20:23], s30 offen
    s_mov_b32 s30, 6912
    buffer_load_dwordx4 v[32:35], v5, s[20:23], s30 offen
    s_mov_b32 s30, 20736
    buffer_load_dwordx4 v[36:39], v5, s[20:23], s30 offen
    s_mov_b32 s30, 34560
    buffer_load_dwordx4 v[40:43], v5, s[20:23], s30 offen
    s_mov_b32 s30, 48384
    buffer_load_dwordx4 v[44:47], v5, s[20:23], s30 offen
    s_waitcnt vmcnt(22)
    s_barrier
    s_add_u32 m0, s32, 3072
    s_add_u32 s30, s34, 3072
    buffer_load_dwordx4 v3, s[12:15], s30 offen  lds
    s_add_u32 m0, s32, 4096
    s_add_u32 s30, s34, 4096
    buffer_load_dwordx4 v3, s[12:15], s30 offen  lds
    s_add_u32 m0, s32, 5120
    s_add_u32 s30, s34, 5120
    buffer_load_dwordx4 v3, s[12:15], s30 offen  lds
    s_add_u32 m0, s32, 6144
    s_add_u32 s30, s34, 6144
    buffer_load_dwordx4 v3, s[12:15], s30 offen  lds
    s_add_u32 m0, s32, 7168
    s_add_u32 s30, s34, 7168
    buffer_load_dwordx4 v3, s[12:15], s30 offen  lds
    s_add_u32 m0, s32, 8192
    s_add_u32 s30, s34, 8192
    buffer_load_dwordx4 v3, s[12:15], s30 offen  lds
    s_add_u32 m0, s32, 9216
    s_add_u32 s30, s34, 9216
    buffer_load_dwordx4 v3, s[12:15], s30 offen  lds
    s_add_u32 m0, s32, 10240
    s_add_u32 s30, s34, 10240
    buffer_load_dwordx4 v3, s[12:15], s30 offen  lds
    s_add_u32 m0, s32, 11264
    s_add_u32 s30, s34, 11264
    buffer_load_dwordx4 v3, s[12:15], s30 offen  lds
    s_add_u32 m0, s32, 12288
    s_add_u32 s30, s34, 12288
    buffer_load_dwordx4 v3, s[12:15], s30 offen  lds
    s_add_u32 m0, s32, 13312
    s_add_u32 s30, s34, 13312
    buffer_load_dwordx4 v3, s[12:15], s30 offen  lds
    s_add_u32 s33, s33, 262144
    s_add_u32 s34, s34, 442368
    s_add_u32 s32, s32, 47104
    s_sub_u32 s31, s32, 141312
    s_cmp_ge_u32 s32, 141312
    s_cselect_b32 s32, s31, s32
    s_waitcnt vmcnt(11)
    v_mov_b32 v198, 0x3f803f80
    v_mov_b32 v192, 0
    v_mov_b32 v193, 0
    v_mov_b32 v194, 0
    v_mov_b32 v195, 0
    v_dot2_f32_bf16 v192, v200, v198, v192
    v_dot2_f32_bf16 v193, v202, v198, v193
    v_dot2_f32_bf16 v194, v200, v200, v194
    v_dot2_f32_bf16 v195, v202, v202, v195
    v_dot2_f32_bf16 v192, v201, v198, v192
    v_dot2_f32_bf16 v193, v203, v198, v193
    v_dot2_f32_bf16 v194, v201, v201, v194
    v_dot2_f32_bf16 v195, v203, v203, v195
    v_dot2_f32_bf16 v192, v204, v198, v192
    v_dot2_f32_bf16 v193, v206, v198, v193
    v_dot2_f32_bf16 v194, v204, v204, v194
    v_dot2_f32_bf16 v195, v206, v206, v195
    v_dot2_f32_bf16 v192, v205, v198, v192
    v_dot2_f32_bf16 v193, v207, v198, v193
    v_dot2_f32_bf16 v194, v205, v205, v194
    v_dot2_f32_bf16 v195, v207, v207, v195
    v_dot2_f32_bf16 v192, v208, v198, v192
    v_dot2_f32_bf16 v193, v210, v198, v193
    v_dot2_f32_bf16 v194, v208, v208, v194
    v_dot2_f32_bf16 v195, v210, v210, v195
    v_dot2_f32_bf16 v192, v209, v198, v192
    v_dot2_f32_bf16 v193, v211, v198, v193
    v_dot2_f32_bf16 v194, v209, v209, v194
    v_dot2_f32_bf16 v195, v211, v211, v195
    v_add_f32_dpp v192, v192, v192 row_ror:1 row_mask:0xf bank_mask:0xf
    s_nop 1
    v_add_f32_dpp v192, v192, v192 row_ror:2 row_mask:0xf bank_mask:0xf
    s_nop 1
    v_add_f32_dpp v192, v192, v192 row_ror:4 row_mask:0xf bank_mask:0xf
    s_nop 1
    v_add_f32_dpp v192, v192, v192 row_ror:8 row_mask:0xf bank_mask:0xf
    v_mov_b32 v197, v192
    s_nop 1
    v_permlane16_swap_b32 v192, v197
    v_add_f32 v192, v192, v197
    v_mov_b32 v197, v192
    s_nop 1
    v_permlane32_swap_b32 v192, v197
    v_add_f32 v192, v192, v197
    v_add_f32_dpp v193, v193, v193 row_ror:1 row_mask:0xf bank_mask:0xf
    s_nop 1
    v_add_f32_dpp v193, v193, v193 row_ror:2 row_mask:0xf bank_mask:0xf
    s_nop 1
    v_add_f32_dpp v193, v193, v193 row_ror:4 row_mask:0xf bank_mask:0xf
    s_nop 1
    v_add_f32_dpp v193, v193, v193 row_ror:8 row_mask:0xf bank_mask:0xf
    v_mov_b32 v197, v193
    s_nop 1
    v_permlane16_swap_b32 v193, v197
    v_add_f32 v193, v193, v197
    v_mov_b32 v197, v193
    s_nop 1
    v_permlane32_swap_b32 v193, v197
    v_add_f32 v193, v193, v197
    v_add_f32_dpp v194, v194, v194 row_ror:1 row_mask:0xf bank_mask:0xf
    s_nop 1
    v_add_f32_dpp v194, v194, v194 row_ror:2 row_mask:0xf bank_mask:0xf
    s_nop 1
    v_add_f32_dpp v194, v194, v194 row_ror:4 row_mask:0xf bank_mask:0xf
    s_nop 1
    v_add_f32_dpp v194, v194, v194 row_ror:8 row_mask:0xf bank_mask:0xf
    v_mov_b32 v197, v194
    s_nop 1
    v_permlane16_swap_b32 v194, v197
    v_add_f32 v194, v194, v197
    v_mov_b32 v197, v194
    s_nop 1
    v_permlane32_swap_b32 v194, v197
    v_add_f32 v194, v194, v197
    v_add_f32_dpp v195, v195, v195 row_ror:1 row_mask:0xf bank_mask:0xf
    s_nop 1
    v_add_f32_dpp v195, v195, v195 row_ror:2 row_mask:0xf bank_mask:0xf
    s_nop 1
    v_add_f32_dpp v195, v195, v195 row_ror:4 row_mask:0xf bank_mask:0xf
    s_nop 1
    v_add_f32_dpp v195, v195, v195 row_ror:8 row_mask:0xf bank_mask:0xf
    v_mov_b32 v197, v195
    s_nop 1
    v_permlane16_swap_b32 v195, v197
    v_add_f32 v195, v195, v197
    v_mov_b32 v197, v195
    s_nop 1
    v_permlane32_swap_b32 v195, v197
    v_add_f32 v195, v195, v197
    v_mul_f32 v192, 0x3acccccd, v192
    v_mul_f32 v193, 0x3acccccd, v193
    v_mul_f32 v194, 0x3acccccd, v194
    v_mul_f32 v195, 0x3acccccd, v195
    v_fma_f32 v194, -v192, v192, v194
    v_fma_f32 v195, -v193, v193, v195
    v_max_f32 v194, 0, v194
    v_max_f32 v195, 0, v195
    v_cvt_pk_bf16_f32 v192, v192, v192
    v_lshlrev_b32 v192, 16, v192
    v_cvt_pk_bf16_f32 v194, v194, v194
    v_lshlrev_b32 v194, 16, v194
    v_add_f32 v194, 0x3727c5ac, v194
    v_cvt_pk_bf16_f32 v194, v194, v194
    v_lshlrev_b32 v194, 16, v194
    v_sqrt_f32 v194, v194
    s_nop 0
    v_cvt_pk_bf16_f32 v194, v194, v194
    v_lshlrev_b32 v194, 16, v194
    v_rcp_f32 v194, v194
    v_cvt_pk_bf16_f32 v193, v193, v193
    v_lshlrev_b32 v193, 16, v193
    v_cvt_pk_bf16_f32 v195, v195, v195
    v_lshlrev_b32 v195, 16, v195
    v_add_f32 v195, 0x3727c5ac, v195
    v_cvt_pk_bf16_f32 v195, v195, v195
    v_lshlrev_b32 v195, 16, v195
    v_sqrt_f32 v195, v195
    s_nop 0
    v_cvt_pk_bf16_f32 v195, v195, v195
    v_lshlrev_b32 v195, 16, v195
    v_rcp_f32 v195, v195
    v_mov_b32 v212, v192
    v_mov_b32 v213, v194
    v_mov_b32 v214, v193
    v_mov_b32 v215, v195
    v_mov_b32 v196, s94
    s_mov_b64 exec, 1
    buffer_store_dwordx4 v[212:215], v196, s[36:39], 0 offen sc1
    s_mov_b64 exec, -1
    v_add_f32 v16, v16, v20
    v_add_f32 v24, v24, v28
    v_add_f32 v16, v16, v24
    v_add_f32 v17, v17, v21
    v_add_f32 v25, v25, v29
    v_add_f32 v17, v17, v25
    v_add_f32 v18, v18, v22
    v_add_f32 v26, v26, v30
    v_add_f32 v18, v18, v26
    v_add_f32 v19, v19, v23
    v_add_f32 v27, v27, v31
    v_add_f32 v19, v19, v27
    v_add_f32 v32, v32, v36
    v_add_f32 v40, v40, v44
    v_add_f32 v32, v32, v40
    v_add_f32 v33, v33, v37
    v_add_f32 v41, v41, v45
    v_add_f32 v33, v33, v41
    v_add_f32 v34, v34, v38
    v_add_f32 v42, v42, v46
    v_add_f32 v34, v34, v42
    v_add_f32 v35, v35, v39
    v_add_f32 v43, v43, v47
    v_add_f32 v35, v35, v43
    v_lshlrev_b32 v6, 4, v1
    v_add_u32 v6, 143360, v6
    s_mov_b64 exec, 0xfffffff
    ds_write_b128 v6, v[16:19]
    ds_write_b128 v6, v[32:35] offset:448
    s_mov_b64 exec, -1
    s_mov_b32 s29, 2
L_g1_ld1_f:
    s_waitcnt vmcnt(11) lgkmcnt(0)
    s_barrier
    s_add_u32 m0, s32, 3072
    s_add_u32 s30, s34, 3072
    buffer_load_dwordx4 v3, s[12:15], s30 offen  lds
    s_add_u32 m0, s32, 4096
    s_add_u32 s30, s34, 4096
    buffer_load_dwordx4 v3, s[12:15], s30 offen  lds
    s_add_u32 m0, s32, 5120
    s_add_u32 s30, s34, 5120
    buffer_load_dwordx4 v3, s[12:15], s30 offen  lds
    s_add_u32 m0, s32, 6144
    s_add_u32 s30, s34, 6144
    buffer_load_dwordx4 v3, s[12:15], s30 offen  lds
    s_add_u32 m0, s32, 7168
    s_add_u32 s30, s34, 7168
    buffer_load_dwordx4 v3, s[12:15], s30 offen  lds
    s_add_u32 m0, s32, 8192
    s_add_u32 s30, s34, 8192
    buffer_load_dwordx4 v3, s[12:15], s30 offen  lds
    s_add_u32 m0, s32, 9216
    s_add_u32 s30, s34, 9216
    buffer_load_dwordx4 v3, s[12:15], s30 offen  lds
    s_add_u32 m0, s32, 10240
    s_add_u32 s30, s34, 10240
    buffer_load_dwordx4 v3, s[12:15], s30 offen  lds
    s_add_u32 m0, s32, 11264
    s_add_u32 s30, s34, 11264
    buffer_load_dwordx4 v3, s[12:15], s30 offen  lds
    s_add_u32 m0, s32, 12288
    s_add_u32 s30, s34, 12288
    buffer_load_dwordx4 v3, s[12:15], s30 offen  lds
    s_add_u32 m0, s32, 13312
    s_add_u32 s30, s34, 13312
    buffer_load_dwordx4 v3, s[12:15], s30 offen  lds
    s_add_u32 s33, s33, 262144
    s_add_u32 s34, s34, 442368
    s_add_u32 s32, s32, 47104
    s_sub_u32 s31, s32, 141312
    s_cmp_ge_u32 s32, 141312
    s_cselect_b32 s32, s31, s32
    s_add_u32 s29, s29, 1
    s_cmp_lt_u32 s29, 8
    s_cbranch_scc1 L_g1_ld1_f
    s_waitcnt vmcnt(11)
    s_barrier
    s_waitcnt vmcnt(0)
    s_barrier
L_g1_ldone_f:
    s_cmp_eq_u32 s24, 4
    s_cbranch_scc0 L_sg_done_f
    v_lshlrev_b32 v6, 4, v1
    s_lshl_b32 s30, s25, 10
    s_mov_b32 s31, 0
L_sg_poll_f:
    buffer_load_dwordx4 v[8:11], v6, s[36:39], s30 offen sc1
    s_waitcnt vmcnt(0)
    v_cmp_eq_u32 vcc, -1, v9
    v_cmp_eq_u32 s[94:95], -1, v11
    s_nop 0
    s_or_b64 vcc, vcc, s[94:95]
    s_cmp_eq_u64 vcc, 0
    s_cbranch_scc1 L_sg_ok_f
    s_add_u32 s31, s31, 1
    s_cmp_lt_u32 s31, 200000
    s_cbranch_scc1 L_sg_poll_f
L_sg_ok_f:
    v_add_u32 v6, 144384, v6
    ds_write_b128 v6, v[8:11]
    s_waitcnt lgkmcnt(0)
L_sg_done_f:
    s_barrier
    s_mov_b32 s95, s25
    s_mov_b32 s86, s26
    s_and_b32 s29, s2, 7
    s_lshr_b32 s30, s2, 3
    s_lshl_b32 s25, s29, 2
    s_and_b32 s26, s30, 3
    s_add_u32 s25, s25, s26
    s_lshr_b32 s26, s30, 2
    s_add_u32 s8, s6, 28311552
    s_addc_u32 s9, s7, 0
    s_mov_b32 s10, 2211840
    s_mov_b32 s11, 131072
    s_add_u32 s12, s6, 9437184
    s_addc_u32 s13, s7, 0
    s_mov_b32 s14, 7077888
    s_mov_b32 s15, 131072
    s_add_u32 s16, s6, 6291456
    s_addc_u32 s17, s7, 0
    s_mov_b32 s18, 2621440
    s_mov_b32 s19, 131072
    s_mov_b32 s20, s92
    s_mov_b32 s21, s93
    s_mov_b32 s22, 2621440
    s_mov_b32 s23, 131072
    s_mul_i32 s29, s26, 5120
    v_lshlrev_b32 v3, 4, v1
    v_add_u32 v3, s29, v3
    s_sub_u32 s28, s24, 4
    s_mul_i32 s32, s28, 40960
    s_mul_i32 s33, s28, 5120
    s_add_u32 m0, s33, 0
    s_add_u32 s29, s32, 0
    buffer_load_dwordx4 v3, s[8:11], s29 offen  lds
    s_add_u32 m0, s33, 1024
    s_add_u32 s29, s32, 1024
    buffer_load_dwordx4 v3, s[8:11], s29 offen  lds
    s_add_u32 m0, s33, 2048
    s_add_u32 s29, s32, 2048
    buffer_load_dwordx4 v3, s[8:11], s29 offen  lds
    s_add_u32 m0, s33, 3072
    s_add_u32 s29, s32, 3072
    buffer_load_dwordx4 v3, s[8:11], s29 offen  lds
    s_add_u32 m0, s33, 4096
    s_add_u32 s29, s32, 4096
    buffer_load_dwordx4 v3, s[8:11], s29 offen  lds
    s_add_u32 s32, s32, 163840
    s_add_u32 s33, s33, 20480
    s_sub_u32 s29, s33, 143360
    s_cmp_ge_u32 s33, 143360
    s_cselect_b32 s33, s29, s33
    s_add_u32 m0, s33, 0
    s_add_u32 s29, s32, 0
    buffer_load_dwordx4 v3, s[8:11], s29 offen  lds
    s_add_u32 m0, s33, 1024
    s_add_u32 s29, s32, 1024
    buffer_load_dwordx4 v3, s[8:11], s29 offen  lds
    s_add_u32 m0, s33, 2048
    s_add_u32 s29, s32, 2048
    buffer_load_dwordx4 v3, s[8:11], s29 offen  lds
    s_add_u32 m0, s33, 3072
    s_add_u32 s29, s32, 3072
    buffer_load_dwordx4 v3, s[8:11], s29 offen  lds
    s_add_u32 m0, s33, 4096
    s_add_u32 s29, s32, 4096
    buffer_load_dwordx4 v3, s[8:11], s29 offen  lds
    s_add_u32 s32, s32, 163840
    s_add_u32 s33, s33, 20480
    s_sub_u32 s29, s33, 143360
    s_cmp_ge_u32 s33, 143360
    s_cselect_b32 s33, s29, s33
    s_add_u32 m0, s33, 0
    s_add_u32 s29, s32, 0
    buffer_load_dwordx4 v3, s[8:11], s29 offen  lds
    s_add_u32 m0, s33, 1024
    s_add_u32 s29, s32, 1024
    buffer_load_dwordx4 v3, s[8:11], s29 offen  lds
    s_add_u32 m0, s33, 2048
    s_add_u32 s29, s32, 2048
    buffer_load_dwordx4 v3, s[8:11], s29 offen  lds
    s_add_u32 m0, s33, 3072
    s_add_u32 s29, s32, 3072
    buffer_load_dwordx4 v3, s[8:11], s29 offen  lds
    s_add_u32 m0, s33, 4096
    s_add_u32 s29, s32, 4096
    buffer_load_dwordx4 v3, s[8:11], s29 offen  lds
    s_add_u32 s32, s32, 163840
    s_add_u32 s33, s33, 20480
    s_sub_u32 s29, s33, 143360
    s_cmp_ge_u32 s33, 143360
    s_cselect_b32 s33, s29, s33
    s_barrier
    s_add_u32 m0, s33, 0
    s_add_u32 s29, s32, 0
    buffer_load_dwordx4 v3, s[8:11], s29 offen  lds
    s_add_u32 m0, s33, 1024
    s_add_u32 s29, s32, 1024
    buffer_load_dwordx4 v3, s[8:11], s29 offen  lds
    s_add_u32 m0, s33, 2048
    s_add_u32 s29, s32, 2048
    buffer_load_dwordx4 v3, s[8:11], s29 offen  lds
    s_add_u32 m0, s33, 3072
    s_add_u32 s29, s32, 3072
    buffer_load_dwordx4 v3, s[8:11], s29 offen  lds
    s_add_u32 m0, s33, 4096
    s_add_u32 s29, s32, 4096
    buffer_load_dwordx4 v3, s[8:11], s29 offen  lds
    s_add_u32 s32, s32, 163840
    s_add_u32 s33, s33, 20480
    s_sub_u32 s29, s33, 143360
    s_cmp_ge_u32 s33, 143360
    s_cselect_b32 s33, s29, s33
    s_add_u32 m0, s33, 0
    s_add_u32 s29, s32, 0
    buffer_load_dwordx4 v3, s[8:11], s29 offen  lds
    s_add_u32 m0, s33, 1024
    s_add_u32 s29, s32, 1024
    buffer_load_dwordx4 v3, s[8:11], s29 offen  lds
    s_add_u32 m0, s33, 2048
    s_add_u32 s29, s32, 2048
    buffer_load_dwordx4 v3, s[8:11], s29 offen  lds
    s_add_u32 m0, s33, 3072
    s_add_u32 s29, s32, 3072
    buffer_load_dwordx4 v3, s[8:11], s29 offen  lds
    s_add_u32 m0, s33, 4096
    s_add_u32 s29, s32, 4096
    buffer_load_dwordx4 v3, s[8:11], s29 offen  lds
    s_add_u32 s32, s32, 163840
    s_add_u32 s33, s33, 20480
    s_sub_u32 s29, s33, 143360
    s_cmp_ge_u32 s33, 143360
    s_cselect_b32 s33, s29, s33
    s_add_u32 m0, s33, 0
    s_add_u32 s29, s32, 0
    buffer_load_dwordx4 v3, s[8:11], s29 offen  lds
    s_add_u32 m0, s33, 1024
    s_add_u32 s29, s32, 1024
    buffer_load_dwordx4 v3, s[8:11], s29 offen  lds
    s_add_u32 m0, s33, 2048
    s_add_u32 s29, s32, 2048
    buffer_load_dwordx4 v3, s[8:11], s29 offen  lds
    s_add_u32 m0, s33, 3072
    s_add_u32 s29, s32, 3072
    buffer_load_dwordx4 v3, s[8:11], s29 offen  lds
    s_add_u32 m0, s33, 4096
    s_add_u32 s29, s32, 4096
    buffer_load_dwordx4 v3, s[8:11], s29 offen  lds
    s_add_u32 s32, s32, 163840
    s_add_u32 s33, s33, 20480
    s_sub_u32 s29, s33, 143360
    s_cmp_ge_u32 s33, 143360
    s_cselect_b32 s33, s29, s33
    s_add_u32 m0, s33, 0
    s_add_u32 s29, s32, 0
    buffer_load_dwordx4 v3, s[8:11], s29 offen  lds
    s_add_u32 m0, s33, 1024
    s_add_u32 s29, s32, 1024
    buffer_load_dwordx4 v3, s[8:11], s29 offen  lds
    s_add_u32 m0, s33, 2048
    s_add_u32 s29, s32, 2048
    buffer_load_dwordx4 v3, s[8:11], s29 offen  lds
    s_add_u32 m0, s33, 3072
    s_add_u32 s29, s32, 3072
    buffer_load_dwordx4 v3, s[8:11], s29 offen  lds
    s_add_u32 m0, s33, 4096
    s_add_u32 s29, s32, 4096
    buffer_load_dwordx4 v3, s[8:11], s29 offen  lds
    s_add_u32 s32, s32, 163840
    s_add_u32 s33, s33, 20480
    s_sub_u32 s29, s33, 143360
    s_cmp_ge_u32 s33, 143360
    s_cselect_b32 s33, s29, s33
    s_waitcnt vmcnt(30)
    s_barrier
    s_waitcnt vmcnt(25)
    s_barrier
    s_waitcnt vmcnt(20)
    s_barrier
    s_add_u32 m0, s33, 0
    s_add_u32 s29, s32, 0
    buffer_load_dwordx4 v3, s[8:11], s29 offen  lds
    s_add_u32 m0, s33, 1024
    s_add_u32 s29, s32, 1024
    buffer_load_dwordx4 v3, s[8:11], s29 offen  lds
    s_add_u32 m0, s33, 2048
    s_add_u32 s29, s32, 2048
    buffer_load_dwordx4 v3, s[8:11], s29 offen  lds
    s_add_u32 m0, s33, 3072
    s_add_u32 s29, s32, 3072
    buffer_load_dwordx4 v3, s[8:11], s29 offen  lds
    s_waitcnt vmcnt(19)
    s_barrier
    s_add_u32 m0, s33, 4096
    s_add_u32 s29, s32, 4096
    buffer_load_dwordx4 v3, s[8:11], s29 offen  lds
    s_add_u32 m0, s33, 20480
    s_add_u32 s29, s32, 163840
    buffer_load_dwordx4 v3, s[8:11], s29 offen  lds
    s_add_u32 m0, s33, 21504
    s_add_u32 s29, s32, 164864
    buffer_load_dwordx4 v3, s[8:11], s29 offen  lds
    s_waitcnt vmcnt(17)
    s_barrier
    s_add_u32 m0, s33, 22528
    s_add_u32 s29, s32, 165888
    buffer_load_dwordx4 v3, s[8:11], s29 offen  lds
    s_add_u32 m0, s33, 23552
    s_add_u32 s29, s32, 166912
    buffer_load_dwordx4 v3, s[8:11], s29 offen  lds
    s_add_u32 m0, s33, 24576
    s_add_u32 s29, s32, 167936
    buffer_load_dwordx4 v3, s[8:11], s29 offen  lds
    s_add_u32 m0, s33, 40960
    s_add_u32 s29, s32, 327680
    buffer_load_dwordx4 v3, s[8:11], s29 offen  lds
    s_waitcnt vmcnt(16)
    s_barrier
    s_add_u32 m0, s33, 41984
    s_add_u32 s29, s32, 328704
    buffer_load_dwordx4 v3, s[8:11], s29 offen  lds
    s_add_u32 m0, s33, 43008
    s_add_u32 s29, s32, 329728
    buffer_load_dwordx4 v3, s[8:11], s29 offen  lds
    s_add_u32 m0, s33, 44032
    s_add_u32 s29, s32, 330752
    buffer_load_dwordx4 v3, s[8:11], s29 offen  lds
    s_waitcnt vmcnt(14)
    s_barrier
    s_add_u32 m0, s33, 45056
    s_add_u32 s29, s32, 331776
    buffer_load_dwordx4 v3, s[8:11], s29 offen  lds
    s_add_u32 m0, s33, 61440
    s_add_u32 s29, s32, 491520
    buffer_load_dwordx4 v3, s[8:11], s29 offen  lds
    s_add_u32 m0, s33, 62464
    s_add_u32 s29, s32, 492544
    buffer_load_dwordx4 v3, s[8:11], s29 offen  lds
    s_add_u32 m0, s33, 63488
    s_add_u32 s29, s32, 493568
    buffer_load_dwordx4 v3, s[8:11], s29 offen  lds
    s_waitcnt vmcnt(13)
    s_barrier
    s_add_u32 m0, s33, 64512
    s_add_u32 s29, s32, 494592
    buffer_load_dwordx4 v3, s[8:11], s29 offen  lds
    s_add_u32 m0, s33, 65536
    s_add_u32 s29, s32, 495616
    buffer_load_dwordx4 v3, s[8:11], s29 offen  lds
    s_add_u32 m0, s33, 81920
    s_add_u32 s29, s32, 655360
    buffer_load_dwordx4 v3, s[8:11], s29 offen  lds
    s_waitcnt vmcnt(11)
    s_barrier
    s_add_u32 m0, s33, 82944
    s_add_u32 s29, s32, 656384
    buffer_load_dwordx4 v3, s[8:11], s29 offen  lds
    s_add_u32 m0, s33, 83968
    s_add_u32 s29, s32, 657408
    buffer_load_dwordx4 v3, s[8:11], s29 offen  lds
    s_add_u32 m0, s33, 84992
    s_add_u32 s29, s32, 658432
    buffer_load_dwordx4 v3, s[8:11], s29 offen  lds
    s_add_u32 m0, s33, 86016
    s_add_u32 s29, s32, 659456
    buffer_load_dwordx4 v3, s[8:11], s29 offen  lds
    s_waitcnt vmcnt(10)
    s_barrier
    s_add_u32 m0, s33, 102400
    s_add_u32 s29, s32, 819200
    buffer_load_dwordx4 v3, s[8:11], s29 offen  lds
    s_add_u32 m0, s33, 103424
    s_add_u32 s29, s32, 820224
    buffer_load_dwordx4 v3, s[8:11], s29 offen  lds
    s_add_u32 m0, s33, 104448
    s_add_u32 s29, s32, 821248
    buffer_load_dwordx4 v3, s[8:11], s29 offen  lds
    s_waitcnt vmcnt(8)
    s_barrier
    s_add_u32 m0, s33, 105472
    s_add_u32 s29, s32, 822272
    buffer_load_dwordx4 v3, s[8:11], s29 offen  lds
    s_add_u32 m0, s33, 106496
    s_add_u32 s29, s32, 823296
    buffer_load_dwordx4 v3, s[8:11], s29 offen  lds
    s_add_u32 m0, s33, 122880
    s_add_u32 s29, s32, 983040
    buffer_load_dwordx4 v3, s[8:11], s29 offen  lds
    s_add_u32 m0, s33, 123904
    s_add_u32 s29, s32, 984064
    buffer_load_dwordx4 v3, s[8:11], s29 offen  lds
    s_waitcnt vmcnt(7)
    s_barrier
    s_add_u32 m0, s33, 124928
    s_add_u32 s29, s32, 985088
    buffer_load_dwordx4 v3, s[8:11], s29 offen  lds
    s_add_u32 m0, s33, 125952
    s_add_u32 s29, s32, 986112
    buffer_load_dwordx4 v3, s[8:11], s29 offen  lds
    s_add_u32 m0, s33, 126976
    s_add_u32 s29, s32, 987136
    buffer_load_dwordx4 v3, s[8:11], s29 offen  lds
    s_waitcnt vmcnt(5)
    s_barrier
    s_waitcnt vmcnt(0)
    s_barrier
    s_waitcnt vmcnt(0)
    s_barrier
    s_barrier
    s_barrier
L_ffn_fin_f:
L_ffn_end_f:
    s_endpgm
L_fm_exit:
    s_endpgm

.section .rodata,"a"
.p2align 6
.amdhsa_kernel sequential_preLN__ssm_conv_s4__glu_gated_swiglu__prompt_kernel
  .amdhsa_next_free_vgpr 256
  .amdhsa_next_free_sgpr 102
  .amdhsa_accum_offset 256
  .amdhsa_group_segment_fixed_size 0
  .amdhsa_kernarg_size 128
  .amdhsa_user_sgpr_count 2
  .amdhsa_user_sgpr_kernarg_segment_ptr 1
  .amdhsa_system_sgpr_workgroup_id_x 1
  .amdhsa_float_denorm_mode_32 3
  .amdhsa_float_denorm_mode_16_64 3
.end_amdhsa_kernel
```
